```python
import torch

def _softmax(x, axis=-1):
    return torch.softmax(x, dim=axis)
def _gelu(x):
    return torch.nn.functional.gelu(x, approximate="tanh")
def _silu(x):
    return torch.nn.functional.silu(x)
def _sigmoid(x):
    return torch.sigmoid(x)
def _layernorm(x, axis=-1, eps=1e-5):
    m = x.mean(dim=axis, keepdim=True)
    v = x.var(dim=axis, keepdim=True, unbiased=False)
    return (x - m) / torch.sqrt(v + eps)
def _scatter_add(tgt, idx, src, axis=0):
    return tgt.clone().index_add_(axis, idx, src)
def _segment_sum(src, seg, n):
    out = torch.zeros((n,) + src.shape[1:], dtype=src.dtype)
    return out.index_add_(0, seg, src)
def _pad(x, pw):
    flat = tuple(v for pair in reversed(pw) for v in pair)
    return torch.nn.functional.pad(x, flat)

kernel_name = 'gated_mix__sliding_block__ssm_conv_h3__prompt'

def setup_inputs():

    _w = (lambda a: (lambda t: t.to(torch.bfloat16) if t.is_floating_point() else t)(torch.as_tensor(a)))
    def _A_setup():
        B, S, D = 1, 2048, 576
        return {
            "x": _w((lambda *s: torch.randn(*s, dtype=torch.bfloat16) * 0.05)(B, S, D)),
            "wqkv": _w((lambda *s: torch.randn(*s, dtype=torch.bfloat16) * 0.8)(D, 3 * D)),
            "wo": _w((lambda *s: torch.randn(*s, dtype=torch.bfloat16) * 0.05)(D, D)),
        }
    _A_in = _A_setup()

    def _B_setup():
        B, S, D = 1, 2048, 576
        ks = 4
        return {
            "q": _w((lambda *s: torch.randn(*s, dtype=torch.bfloat16) * 0.05)(B, S, D)),
            "k": _w((lambda *s: torch.randn(*s, dtype=torch.bfloat16) * 0.8)(B, S, D)),
            "v": _w((lambda *s: torch.randn(*s, dtype=torch.bfloat16) * 0.8)(B, S, D)),
            "shift_k": _w((lambda *s: torch.randn(*s, dtype=torch.bfloat16) * 0.8)(D, ks) * 0.5),
            "ssm_k": _w((lambda *s: torch.randn(*s, dtype=torch.bfloat16) * 1.6)(D, S) * (1.0 / S ** 0.5)),
            "ssm_D": _w((lambda *s: torch.randn(*s, dtype=torch.bfloat16) * 0.8)(D)),
        }
    _B_in = _B_setup()

    return {
        "A_x": _A_in["x"],
        "A_wqkv": _A_in["wqkv"],
        "A_wo": _A_in["wo"],
        "B_q": _B_in["q"],
        "B_k": _B_in["k"],
        "B_v": _B_in["v"],
        "B_shift_k": _B_in["shift_k"],
        "B_ssm_k": _B_in["ssm_k"],
        "B_ssm_D": _B_in["ssm_D"],
        "gate_w": _w((lambda *s: torch.randn(*s, dtype=torch.bfloat16) * 0.05)(576) * 16.0),
    }

def reference(A_x, A_wqkv, A_wo, B_q, B_k, B_v, B_shift_k, B_ssm_k, B_ssm_D, gate_w):
    def _A_ref(x, wqkv, wo):
        B, S, D = x.shape
        H = 32; Dh = D // H; W = 256
        qkv = (lambda x, *d: x.permute(*d))((x @ wqkv).reshape(B, S, 3, H, Dh), 2, 0, 3, 1, 4)
        q, k, v = qkv[0], qkv[1], qkv[2]
        scores = torch.einsum("bhqd,bhkd->bhqk", q, k) * (Dh ** -0.5)
        idx = torch.arange(S)
        mask = (idx[:, None] - idx[None, :] >= 0) & (idx[:, None] - idx[None, :] < W)
        scores = torch.where(mask[None, None], scores, -1e9)
        p = _softmax(scores, axis=-1)
        o = torch.einsum("bhqk,bhkd->bhqd", p, v)
        return (lambda x, *d: x.permute(*d))(o, 0, 2, 1, 3).reshape(B, S, D) @ wo

    def _B_ref(q, k, v, shift_k, ssm_k, ssm_D):
        B, S, D = q.shape
        ks = shift_k.shape[-1]
        k_pad = _pad(k, ((0, 0), (ks - 1, 0), (0, 0)))
        k_shift = torch.zeros_like(k)
        for t in range(ks):
            k_shift = k_shift + k_pad[:, t:t + S, :] * shift_k[:, ks - 1 - t][None, None, :]
        kv = k_shift * v
        L = 2 * S
        kv_pad = _pad(kv, ((0, 0), (0, S), (0, 0)))
        kf_pad = _pad(ssm_k, ((0, 0), (0, S)))
        kv_f = (lambda x, axes=(-2,-1): torch.fft.rfft2(x.float(), dim=axes))(kv_pad[:, None, :, :], axes=(1, 2))
        kf_f = (lambda x, axes=(-2,-1): torch.fft.rfft2(x.float(), dim=axes))(kf_pad[:, None, :], axes=(1, 2))
        kf_f = (lambda x, *d: x.permute(*d))(kf_f, 1, 2, 0)
        y_f = kv_f * kf_f[None, :, :, :]
        y = (lambda x, s, axes=(-2,-1): torch.fft.irfft2(x, s=s, dim=axes).to(torch.bfloat16))(y_f, (1, L), axes=(1, 2))[:, 0, :S, :]
        y = y + kv * ssm_D[None, None, :]
        return q * y

    x = A_x
    g = _sigmoid((x * gate_w).sum(-1, keepdims=True))
    a = _A_ref(x, A_wqkv, A_wo)
    b = _B_ref(x, B_k, B_v, B_shift_k, B_ssm_k, B_ssm_D)
    return g * a + (1 - g) * b
```

```asm
; @launch grid=(256,1,1) block=(512,1,1) lds=163840
.amdgcn_target "amdgcn-amd-amdhsa--gfx950"
.text
.globl gated_mix__sliding_block__ssm_conv_h3__prompt_kernel
.p2align 8
.type gated_mix__sliding_block__ssm_conv_h3__prompt_kernel,@function
gated_mix__sliding_block__ssm_conv_h3__prompt_kernel:
    s_cmp_ge_u32 s2, 256
    s_cbranch_scc1 f_exit
    s_load_dwordx4 s[56:59], s[0:1], 0
    s_load_dwordx4 s[60:63], s[0:1], 32
    s_load_dwordx2 s[64:65], s[0:1], 48
    s_load_dwordx2 s[66:67], s[0:1], 88
    s_load_dwordx2 s[4:5], s[0:1], 96
    s_load_dwordx4 s[80:83], s[0:1], 56
    s_load_dwordx2 s[84:85], s[0:1], 72
    s_load_dwordx2 s[86:87], s[0:1], 0
    s_load_dwordx2 s[88:89], s[0:1], 16
    s_memrealtime s[70:71]
    v_lshrrev_b32 v2, 6, v0
    v_and_b32 v1, 63, v0
    v_readfirstlane_b32 s3, v2
    s_lshr_b32 s46, s2, 3
    v_mov_b32 v255, 163712
    s_cmp_lt_u32 s46, 28
    s_cbranch_scc1 f_nopf
    s_getpc_b64 s[32:33]
f_pc:
    s_sub_u32 s32, s32, f_pc-gated_mix__sliding_block__ssm_conv_h3__prompt_kernel
    s_subb_u32 s33, s33, 0
    s_sub_u32 s52, s46, 28
    s_lshl_b32 s52, s52, 13
    v_lshl_add_u32 v3, v0, 4, s52
    s_mov_b32 s53, code_end-gated_mix__sliding_block__ssm_conv_h3__prompt_kernel
    v_cmp_gt_u32 vcc, s53, v3
    s_and_saveexec_b64 s[34:35], vcc
    s_cbranch_execz f_pf2
    global_load_dwordx4 v[160:163], v3, s[32:33]
f_pf2:
    s_mov_b64 exec, -1
f_nopf:
    s_mul_i32 s52, s46, 37
    s_lshr_b32 s52, s52, 8
    s_mul_i32 s53, s52, 7
    s_sub_u32 s45, s46, s53
    s_bfe_u32 s54, s2, 0x20001
    s_lshl_b32 s44, s54, 2
    s_add_u32 s44, s44, s52
    s_and_b32 s54, s2, 1
    s_mul_i32 s43, s54, 288
    s_cmp_ge_u32 s46, 28
    s_cbranch_scc1 f_spare
    s_cmp_lt_u32 s3, 4
    s_cbranch_scc1 f_compute
    s_lshl_b32 s53, s45, 2
    s_lshl_b32 s52, s52, 1
    s_add_u32 s76, s52, s53
    s_mul_i32 s52, s76, 57
    s_lshr_b32 s52, s52, 9
    s_mul_i32 s52, s52, 9
    s_sub_u32 s76, s76, s52
    s_sub_u32 s68, s3, 4
    v_lshrrev_b32 v2, 3, v1
    v_and_b32 v3, 7, v1
    v_lshrrev_b32 v4, 1, v2
    v_xor_b32 v3, v3, v4
    v_lshrrev_b32 v4, 2, v2
    v_and_b32 v5, 3, v2
    v_lshl_add_u32 v4, v4, 4, v5
    s_lshl_b32 s52, s44, 7
    s_lshl_b32 s53, s68, 5
    s_add_u32 s52, s52, s53
    v_add_u32 v4, s52, v4
    v_mul_u32_u24 v4, 1152, v4
    v_lshl_add_u32 v16, v3, 4, v4
    v_xor_b32 v17, 64, v16
    v_lshrrev_b32 v2, 4, v1
    v_bfe_u32 v3, v1, 2, 2
    v_xor_b32 v3, v3, v2
    s_lshl_b32 s55, s45, 2
    s_and_b32 s39, s2, 1
    s_sub_u32 s55, s55, s39
    v_add_u32 v3, s55, v3
    v_min_u32 v3, 27, v3
    v_mul_u32_u24 v4, 57, v3
    v_lshrrev_b32 v4, 9, v4
    v_mul_u32_u24 v4, 288, v4
    v_lshl_add_u32 v3, v3, 5, v4
    v_add_u32 v3, s43, v3
    s_lshl_b32 s52, s68, 4
    v_add_u32 v2, s52, v2
    v_mul_u32_u24 v2, 3456, v2
    v_lshl_add_u32 v2, v3, 1, v2
    v_and_b32 v3, 3, v1
    v_lshl_add_u32 v18, v3, 4, v2
    s_lshl_b32 s73, s68, 12
    s_add_u32 s77, s73, 32768
    s_mov_b32 s74, 0
    s_waitcnt lgkmcnt(0)
    s_mov_b32 s8, s56
    s_and_b32 s9, s57, 0xffff
    s_mov_b32 s10, 2359296
    s_mov_b32 s11, 0x00020000
    s_mov_b32 s12, s58
    s_and_b32 s13, s59, 0xffff
    s_mov_b32 s14, 1990656
    s_mov_b32 s15, 0x00020000
    s_branch f_issue
f_ldloop:
    s_cmp_lt_u32 s74, 2
    s_cbranch_scc1 f_issue
    s_waitcnt vmcnt(8)
    s_barrier
f_issue:
    s_lshl_b32 s69, s76, 7
    s_mul_i32 s72, s76, 221184
    s_add_u32 m0, s77, 0
    s_nop 0
    buffer_load_dwordx4 v16, s[8:11], s69 offen lds
    s_add_u32 m0, s77, 16384
    s_nop 0
    buffer_load_dwordx4 v18, s[12:15], s72 offen lds
    s_add_u32 m0, s77, 1024
    s_add_u32 s69, s69, 4608
    buffer_load_dwordx4 v17, s[8:11], s69 offen lds
    s_add_u32 m0, s77, 17408
    s_add_u32 s72, s72, 13824
    buffer_load_dwordx4 v18, s[12:15], s72 offen lds
    s_add_u32 m0, s77, 2048
    s_add_u32 s69, s69, 4608
    buffer_load_dwordx4 v16, s[8:11], s69 offen lds
    s_add_u32 m0, s77, 18432
    s_add_u32 s72, s72, 13824
    buffer_load_dwordx4 v18, s[12:15], s72 offen lds
    s_add_u32 m0, s77, 3072
    s_add_u32 s69, s69, 4608
    buffer_load_dwordx4 v17, s[8:11], s69 offen lds
    s_add_u32 m0, s77, 19456
    s_add_u32 s72, s72, 13824
    buffer_load_dwordx4 v18, s[12:15], s72 offen lds
    s_add_u32 s76, s76, 1
    s_cmp_eq_u32 s76, 9
    s_cselect_b32 s76, 0, s76
    s_add_u32 s77, s77, 32768
    s_cmp_ge_u32 s77, 131072
    s_cselect_b32 s77, s73, s77
    s_add_u32 s74, s74, 1
    s_mov_b32 s75, 1
    s_cmp_eq_u32 s74, 2
    s_cbranch_scc1 f_service
    s_cmp_lt_u32 s74, 9
    s_cbranch_scc1 f_ldloop
    s_branch f_service2
f_spare:
    s_and_b32 s52, s2, 7
    s_lshl_b32 s52, s52, 2
    s_add_u32 s52, s52, s46
    s_sub_u32 s52, s52, 28
    s_mul_i32 s42, s52, 18
    s_mov_b32 s73, s3
    s_lshl_b32 s76, s3, 12
    v_and_b32 v4, 31, v1
    v_lshl_add_u32 v4, v4, 2, v255
    v_mov_b32 v5, 0
    ds_write_b32 v4, v5
    v_and_b32 v2, 7, v1
    v_lshrrev_b32 v3, 3, v1
    v_mul_u32_u24 v10, 4608, v3
    v_lshl_add_u32 v10, v2, 4, v10
    v_lshlrev_b32 v11, 6, v2
    v_and_b32 v2, 7, v1
    v_lshrrev_b32 v3, 3, v1
    v_subrev_u32 v12, 8, v1
    v_lshlrev_b32 v12, 2, v12
    v_lshrrev_b32 v4, 1, v3
    v_and_b32 v5, 3, v2
    v_xor_b32 v4, v4, v5
    v_lshlrev_b32 v5, 9, v2
    v_lshl_add_u32 v5, v4, 4, v5
    v_and_b32 v4, 1, v3
    v_xor_b32 v4, 1, v4
    v_lshl_add_u32 v5, v4, 3, v5
    v_add_u32 v13, s76, v5
    v_lshrrev_b32 v6, 5, v1
    v_xor_b32 v6, v6, v1
    v_lshl_add_u32 v16, v6, 4, s76
    v_xor_b32 v17, 32, v16
    v_lshlrev_b32 v14, 13, v3
    v_lshl_add_u32 v14, v2, 4, v14
    s_mov_b32 s40, 0xffff0000
    s_waitcnt lgkmcnt(0)
    s_mov_b32 s20, s60
    s_and_b32 s21, s61, 0xffff
    s_mov_b32 s22, 2359296
    s_mov_b32 s23, 0x00020000
    s_mov_b32 s24, s62
    s_and_b32 s25, s63, 0xffff
    s_mov_b32 s26, 2359296
    s_mov_b32 s27, 0x00020000
    s_mov_b32 s28, s64
    s_and_b32 s29, s65, 0xffff
    s_mov_b32 s30, 4608
    s_mov_b32 s31, 0x00020000
    s_add_u32 s36, s4, 8388608
    s_addc_u32 s37, s5, 0
    s_and_b32 s37, s37, 0xffff
    s_mov_b32 s38, 2359296
    s_mov_b32 s39, 0x00020000
    s_add_u32 s32, s4, 25165824
    s_addc_u32 s33, s5, 0
    s_and_b32 s33, s33, 0xffff
    s_mov_b32 s34, 655360
    s_mov_b32 s35, 0x00020000
    s_mov_b32 s77, -1
    s_barrier
f_ploop:
    s_cmp_ge_u32 s73, 9
    s_cselect_b32 s53, 9, 0
    s_sub_u32 s52, s73, s53
    s_add_u32 s52, s52, 6
    s_cmp_ge_u32 s52, 9
    s_cselect_b32 s54, 9, 0
    s_sub_u32 s52, s52, s54
    s_add_u32 s52, s52, s53
    s_add_u32 s72, s42, s52
    s_mul_i32 s52, s72, 7282
    s_lshr_b32 s52, s52, 16
    s_mul_i32 s53, s52, 9
    s_sub_u32 s53, s72, s53
    s_mul_i32 s54, s52, 36864
    s_lshl_b32 s55, s53, 7
    s_add_u32 s54, s54, s55
    buffer_load_dwordx4 v[32:35], v10, s[20:23], s54 offen offset:0
    buffer_load_dwordx4 v[36:39], v10, s[20:23], s54 offen offset:1152
    buffer_load_dwordx4 v[40:43], v10, s[20:23], s54 offen offset:2304
    buffer_load_dwordx4 v[44:47], v10, s[20:23], s54 offen offset:3456
    buffer_load_dwordx4 v[48:51], v10, s[24:27], s54 offen offset:0
    buffer_load_dwordx4 v[52:55], v10, s[24:27], s54 offen offset:1152
    buffer_load_dwordx4 v[56:59], v10, s[24:27], s54 offen offset:2304
    buffer_load_dwordx4 v[60:63], v10, s[24:27], s54 offen offset:3456
    s_sub_u32 s54, s54, 3456
    v_add_u32 v7, s54, v10
    s_lshl_b32 s55, s53, 9
    buffer_load_dwordx4 v[64:67], v11, s[28:31], s55 offen offset:0
    buffer_load_dwordx4 v[68:71], v11, s[28:31], s55 offen offset:16
    buffer_load_dwordx4 v[72:75], v11, s[28:31], s55 offen offset:32
    buffer_load_dwordx4 v[76:79], v11, s[28:31], s55 offen offset:48
    buffer_load_dwordx4 v[20:23], v7, s[20:23], 0 offen offset:0
    buffer_load_dwordx4 v[24:27], v7, s[20:23], 0 offen offset:1152
    buffer_load_dwordx4 v[28:31], v7, s[20:23], 0 offen offset:2304
    s_cmp_lg_i32 s77, -1
    s_cbranch_scc1 f_pp1
    s_cmp_lg_u32 s3, 2
    s_cbranch_scc1 f_pp2
    s_mov_b32 s8, s66
    s_and_b32 s9, s67, 0xffff
    s_mov_b32 s10, 256
    s_mov_b32 s11, 0x00020000
    v_mov_b32 v2, 0
    s_mov_b32 s54, 65536
f_non1:
    buffer_load_dwordx2 v[4:5], v2, s[8:11], 0 offen sc1
    s_sub_u32 s54, s54, 1
    s_cbranch_scc1 f_non1_x
    s_waitcnt vmcnt(0)
    v_cmp_ne_u32 vcc, 0, v4
    s_cbranch_vccnz f_non1_x
    s_sleep 4
    s_branch f_non1
f_non1_x:
    ds_write_b64 v255, v[4:5] offset:40
    s_waitcnt lgkmcnt(0)
    s_branch f_pp2
f_pp1:
    s_mov_b32 s94, 1048576
f_ln_1:
    ds_read_b64 v[4:5], v255 offset:40
    s_sub_u32 s94, s94, 1
    s_cbranch_scc1 f_ln_1_x
    s_waitcnt lgkmcnt(0)
    v_readfirstlane_b32 s100, v4
    v_readfirstlane_b32 s101, v5
    s_cmp_eq_u32 s100, 0
    s_cbranch_scc1 f_ln_1
f_ln_1_x:
    s_waitcnt vmcnt(0)
    v_mov_b32 v2, s100
    v_mov_b32 v3, s101
    v_mov_b32 v4, 0
    s_mov_b64 exec, 1
    buffer_store_dwordx2 v[2:3], v4, s[32:35], s77 offen sc1
    s_mov_b64 exec, -1
    s_branch f_pp3
f_pp2:
    s_waitcnt vmcnt(0)
f_pp3:
    s_lshl_b32 s53, s53, 6
    s_add_u32 s77, s53, s52
    s_lshl_b32 s77, s77, 7
    v_lshlrev_b32 v80, 16, v64
    v_and_b32 v82, s40, v64
    v_lshlrev_b32 v84, 16, v65
    v_and_b32 v86, s40, v65
    v_lshlrev_b32 v81, 16, v66
    v_and_b32 v83, s40, v66
    v_lshlrev_b32 v85, 16, v67
    v_and_b32 v87, s40, v67
    v_lshlrev_b32 v88, 16, v20
    v_and_b32 v89, s40, v20
    v_lshlrev_b32 v90, 16, v24
    v_and_b32 v91, s40, v24
    v_lshlrev_b32 v92, 16, v28
    v_and_b32 v93, s40, v28
    v_lshlrev_b32 v94, 16, v32
    v_and_b32 v95, s40, v32
    v_lshlrev_b32 v96, 16, v36
    v_and_b32 v97, s40, v36
    v_lshlrev_b32 v98, 16, v40
    v_and_b32 v99, s40, v40
    v_lshlrev_b32 v100, 16, v44
    v_and_b32 v101, s40, v44
    v_lshlrev_b32 v102, 16, v48
    v_and_b32 v103, s40, v48
    v_lshlrev_b32 v104, 16, v52
    v_and_b32 v105, s40, v52
    v_lshlrev_b32 v106, 16, v56
    v_and_b32 v107, s40, v56
    v_lshlrev_b32 v108, 16, v60
    v_and_b32 v109, s40, v60
    v_pk_mul_f32 v[110:111], v[88:89], v[86:87]
    v_pk_mul_f32 v[112:113], v[90:91], v[86:87]
    v_pk_mul_f32 v[114:115], v[92:93], v[86:87]
    v_pk_mul_f32 v[116:117], v[94:95], v[86:87]
    v_pk_fma_f32 v[110:111], v[90:91], v[84:85], v[110:111]
    v_pk_fma_f32 v[112:113], v[92:93], v[84:85], v[112:113]
    v_pk_fma_f32 v[114:115], v[94:95], v[84:85], v[114:115]
    v_pk_fma_f32 v[116:117], v[96:97], v[84:85], v[116:117]
    v_pk_fma_f32 v[110:111], v[92:93], v[82:83], v[110:111]
    v_pk_fma_f32 v[112:113], v[94:95], v[82:83], v[112:113]
    v_pk_fma_f32 v[114:115], v[96:97], v[82:83], v[114:115]
    v_pk_fma_f32 v[116:117], v[98:99], v[82:83], v[116:117]
    v_pk_fma_f32 v[110:111], v[94:95], v[80:81], v[110:111]
    v_pk_fma_f32 v[112:113], v[96:97], v[80:81], v[112:113]
    v_pk_fma_f32 v[114:115], v[98:99], v[80:81], v[114:115]
    v_pk_fma_f32 v[116:117], v[100:101], v[80:81], v[116:117]
    v_pk_mul_f32 v[110:111], v[110:111], v[102:103]
    v_pk_mul_f32 v[112:113], v[112:113], v[104:105]
    v_pk_mul_f32 v[114:115], v[114:115], v[106:107]
    v_pk_mul_f32 v[116:117], v[116:117], v[108:109]
    v_cvt_pk_bf16_f32 v118, v116, v114
    v_cvt_pk_bf16_f32 v119, v112, v110
    v_cvt_pk_bf16_f32 v120, v117, v115
    v_cvt_pk_bf16_f32 v121, v113, v111
    ds_write_b64 v13, v[118:119] offset:0
    ds_write_b64 v13, v[120:121] offset:64
    v_lshlrev_b32 v80, 16, v68
    v_and_b32 v82, s40, v68
    v_lshlrev_b32 v84, 16, v69
    v_and_b32 v86, s40, v69
    v_lshlrev_b32 v81, 16, v70
    v_and_b32 v83, s40, v70
    v_lshlrev_b32 v85, 16, v71
    v_and_b32 v87, s40, v71
    v_lshlrev_b32 v88, 16, v21
    v_and_b32 v89, s40, v21
    v_lshlrev_b32 v90, 16, v25
    v_and_b32 v91, s40, v25
    v_lshlrev_b32 v92, 16, v29
    v_and_b32 v93, s40, v29
    v_lshlrev_b32 v94, 16, v33
    v_and_b32 v95, s40, v33
    v_lshlrev_b32 v96, 16, v37
    v_and_b32 v97, s40, v37
    v_lshlrev_b32 v98, 16, v41
    v_and_b32 v99, s40, v41
    v_lshlrev_b32 v100, 16, v45
    v_and_b32 v101, s40, v45
    v_lshlrev_b32 v102, 16, v49
    v_and_b32 v103, s40, v49
    v_lshlrev_b32 v104, 16, v53
    v_and_b32 v105, s40, v53
    v_lshlrev_b32 v106, 16, v57
    v_and_b32 v107, s40, v57
    v_lshlrev_b32 v108, 16, v61
    v_and_b32 v109, s40, v61
    v_pk_mul_f32 v[110:111], v[88:89], v[86:87]
    v_pk_mul_f32 v[112:113], v[90:91], v[86:87]
    v_pk_mul_f32 v[114:115], v[92:93], v[86:87]
    v_pk_mul_f32 v[116:117], v[94:95], v[86:87]
    v_pk_fma_f32 v[110:111], v[90:91], v[84:85], v[110:111]
    v_pk_fma_f32 v[112:113], v[92:93], v[84:85], v[112:113]
    v_pk_fma_f32 v[114:115], v[94:95], v[84:85], v[114:115]
    v_pk_fma_f32 v[116:117], v[96:97], v[84:85], v[116:117]
    v_pk_fma_f32 v[110:111], v[92:93], v[82:83], v[110:111]
    v_pk_fma_f32 v[112:113], v[94:95], v[82:83], v[112:113]
    v_pk_fma_f32 v[114:115], v[96:97], v[82:83], v[114:115]
    v_pk_fma_f32 v[116:117], v[98:99], v[82:83], v[116:117]
    v_pk_fma_f32 v[110:111], v[94:95], v[80:81], v[110:111]
    v_pk_fma_f32 v[112:113], v[96:97], v[80:81], v[112:113]
    v_pk_fma_f32 v[114:115], v[98:99], v[80:81], v[114:115]
    v_pk_fma_f32 v[116:117], v[100:101], v[80:81], v[116:117]
    v_pk_mul_f32 v[110:111], v[110:111], v[102:103]
    v_pk_mul_f32 v[112:113], v[112:113], v[104:105]
    v_pk_mul_f32 v[114:115], v[114:115], v[106:107]
    v_pk_mul_f32 v[116:117], v[116:117], v[108:109]
    v_cvt_pk_bf16_f32 v122, v116, v114
    v_cvt_pk_bf16_f32 v123, v112, v110
    v_cvt_pk_bf16_f32 v124, v117, v115
    v_cvt_pk_bf16_f32 v125, v113, v111
    ds_write_b64 v13, v[122:123] offset:128
    ds_write_b64 v13, v[124:125] offset:192
    v_lshlrev_b32 v80, 16, v72
    v_and_b32 v82, s40, v72
    v_lshlrev_b32 v84, 16, v73
    v_and_b32 v86, s40, v73
    v_lshlrev_b32 v81, 16, v74
    v_and_b32 v83, s40, v74
    v_lshlrev_b32 v85, 16, v75
    v_and_b32 v87, s40, v75
    v_lshlrev_b32 v88, 16, v22
    v_and_b32 v89, s40, v22
    v_lshlrev_b32 v90, 16, v26
    v_and_b32 v91, s40, v26
    v_lshlrev_b32 v92, 16, v30
    v_and_b32 v93, s40, v30
    v_lshlrev_b32 v94, 16, v34
    v_and_b32 v95, s40, v34
    v_lshlrev_b32 v96, 16, v38
    v_and_b32 v97, s40, v38
    v_lshlrev_b32 v98, 16, v42
    v_and_b32 v99, s40, v42
    v_lshlrev_b32 v100, 16, v46
    v_and_b32 v101, s40, v46
    v_lshlrev_b32 v102, 16, v50
    v_and_b32 v103, s40, v50
    v_lshlrev_b32 v104, 16, v54
    v_and_b32 v105, s40, v54
    v_lshlrev_b32 v106, 16, v58
    v_and_b32 v107, s40, v58
    v_lshlrev_b32 v108, 16, v62
    v_and_b32 v109, s40, v62
    v_pk_mul_f32 v[110:111], v[88:89], v[86:87]
    v_pk_mul_f32 v[112:113], v[90:91], v[86:87]
    v_pk_mul_f32 v[114:115], v[92:93], v[86:87]
    v_pk_mul_f32 v[116:117], v[94:95], v[86:87]
    v_pk_fma_f32 v[110:111], v[90:91], v[84:85], v[110:111]
    v_pk_fma_f32 v[112:113], v[92:93], v[84:85], v[112:113]
    v_pk_fma_f32 v[114:115], v[94:95], v[84:85], v[114:115]
    v_pk_fma_f32 v[116:117], v[96:97], v[84:85], v[116:117]
    v_pk_fma_f32 v[110:111], v[92:93], v[82:83], v[110:111]
    v_pk_fma_f32 v[112:113], v[94:95], v[82:83], v[112:113]
    v_pk_fma_f32 v[114:115], v[96:97], v[82:83], v[114:115]
    v_pk_fma_f32 v[116:117], v[98:99], v[82:83], v[116:117]
    v_pk_fma_f32 v[110:111], v[94:95], v[80:81], v[110:111]
    v_pk_fma_f32 v[112:113], v[96:97], v[80:81], v[112:113]
    v_pk_fma_f32 v[114:115], v[98:99], v[80:81], v[114:115]
    v_pk_fma_f32 v[116:117], v[100:101], v[80:81], v[116:117]
    v_pk_mul_f32 v[110:111], v[110:111], v[102:103]
    v_pk_mul_f32 v[112:113], v[112:113], v[104:105]
    v_pk_mul_f32 v[114:115], v[114:115], v[106:107]
    v_pk_mul_f32 v[116:117], v[116:117], v[108:109]
    v_cvt_pk_bf16_f32 v118, v116, v114
    v_cvt_pk_bf16_f32 v119, v112, v110
    v_cvt_pk_bf16_f32 v120, v117, v115
    v_cvt_pk_bf16_f32 v121, v113, v111
    ds_write_b64 v13, v[118:119] offset:256
    ds_write_b64 v13, v[120:121] offset:320
    v_lshlrev_b32 v80, 16, v76
    v_and_b32 v82, s40, v76
    v_lshlrev_b32 v84, 16, v77
    v_and_b32 v86, s40, v77
    v_lshlrev_b32 v81, 16, v78
    v_and_b32 v83, s40, v78
    v_lshlrev_b32 v85, 16, v79
    v_and_b32 v87, s40, v79
    v_lshlrev_b32 v88, 16, v23
    v_and_b32 v89, s40, v23
    v_lshlrev_b32 v90, 16, v27
    v_and_b32 v91, s40, v27
    v_lshlrev_b32 v92, 16, v31
    v_and_b32 v93, s40, v31
    v_lshlrev_b32 v94, 16, v35
    v_and_b32 v95, s40, v35
    v_lshlrev_b32 v96, 16, v39
    v_and_b32 v97, s40, v39
    v_lshlrev_b32 v98, 16, v43
    v_and_b32 v99, s40, v43
    v_lshlrev_b32 v100, 16, v47
    v_and_b32 v101, s40, v47
    v_lshlrev_b32 v102, 16, v51
    v_and_b32 v103, s40, v51
    v_lshlrev_b32 v104, 16, v55
    v_and_b32 v105, s40, v55
    v_lshlrev_b32 v106, 16, v59
    v_and_b32 v107, s40, v59
    v_lshlrev_b32 v108, 16, v63
    v_and_b32 v109, s40, v63
    v_pk_mul_f32 v[110:111], v[88:89], v[86:87]
    v_pk_mul_f32 v[112:113], v[90:91], v[86:87]
    v_pk_mul_f32 v[114:115], v[92:93], v[86:87]
    v_pk_mul_f32 v[116:117], v[94:95], v[86:87]
    v_pk_fma_f32 v[110:111], v[90:91], v[84:85], v[110:111]
    v_pk_fma_f32 v[112:113], v[92:93], v[84:85], v[112:113]
    v_pk_fma_f32 v[114:115], v[94:95], v[84:85], v[114:115]
    v_pk_fma_f32 v[116:117], v[96:97], v[84:85], v[116:117]
    v_pk_fma_f32 v[110:111], v[92:93], v[82:83], v[110:111]
    v_pk_fma_f32 v[112:113], v[94:95], v[82:83], v[112:113]
    v_pk_fma_f32 v[114:115], v[96:97], v[82:83], v[114:115]
    v_pk_fma_f32 v[116:117], v[98:99], v[82:83], v[116:117]
    v_pk_fma_f32 v[110:111], v[94:95], v[80:81], v[110:111]
    v_pk_fma_f32 v[112:113], v[96:97], v[80:81], v[112:113]
    v_pk_fma_f32 v[114:115], v[98:99], v[80:81], v[114:115]
    v_pk_fma_f32 v[116:117], v[100:101], v[80:81], v[116:117]
    v_pk_mul_f32 v[110:111], v[110:111], v[102:103]
    v_pk_mul_f32 v[112:113], v[112:113], v[104:105]
    v_pk_mul_f32 v[114:115], v[114:115], v[106:107]
    v_pk_mul_f32 v[116:117], v[116:117], v[108:109]
    v_cvt_pk_bf16_f32 v122, v116, v114
    v_cvt_pk_bf16_f32 v123, v112, v110
    v_cvt_pk_bf16_f32 v124, v117, v115
    v_cvt_pk_bf16_f32 v125, v113, v111
    ds_write_b64 v13, v[122:123] offset:384
    ds_write_b64 v13, v[124:125] offset:448
    v_mov_b32 v2, 1
    s_mov_b64 exec, 1
    ds_add_rtn_u32 v3, v255, v2 offset:36
    s_mov_b64 exec, -1
    s_mul_i32 s52, s72, 7282
    s_lshr_b32 s52, s52, 16
    s_mul_i32 s53, s52, 9
    s_sub_u32 s53, s72, s53
    s_lshl_b32 s54, s52, 7
    s_lshl_b32 s55, s53, 18
    s_add_u32 s54, s54, s55
    ds_read_b128 v[128:131], v16 offset:0
    ds_read_b128 v[132:135], v17 offset:1024
    ds_read_b128 v[136:139], v16 offset:2048
    ds_read_b128 v[140:143], v17 offset:3072
    s_waitcnt lgkmcnt(3)
    buffer_store_dwordx4 v[128:131], v14, s[36:39], s54 offen sc1
    s_add_u32 s54, s54, 65536
    s_waitcnt lgkmcnt(2)
    buffer_store_dwordx4 v[132:135], v14, s[36:39], s54 offen sc1
    s_add_u32 s54, s54, 65536
    s_waitcnt lgkmcnt(1)
    buffer_store_dwordx4 v[136:139], v14, s[36:39], s54 offen sc1
    s_add_u32 s54, s54, 65536
    s_waitcnt lgkmcnt(0)
    buffer_store_dwordx4 v[140:143], v14, s[36:39], s54 offen sc1
    s_add_u32 s54, s54, 65536
    v_readfirstlane_b32 s73, v3
    s_add_u32 s73, s73, 8
    s_cmp_lt_u32 s73, 18
    s_cbranch_scc1 f_ploop
    s_mov_b32 s94, 1048576
f_ln_2:
    ds_read_b64 v[4:5], v255 offset:40
    s_sub_u32 s94, s94, 1
    s_cbranch_scc1 f_ln_2_x
    s_waitcnt lgkmcnt(0)
    v_readfirstlane_b32 s100, v4
    v_readfirstlane_b32 s101, v5
    s_cmp_eq_u32 s100, 0
    s_cbranch_scc1 f_ln_2
f_ln_2_x:
    v_mov_b32 v2, 1
    s_mov_b64 exec, 1
    ds_add_u32 v255, v2 offset:56
    s_mov_b64 exec, -1
    s_waitcnt vmcnt(0)
    v_mov_b32 v2, s100
    v_mov_b32 v3, s101
    v_mov_b32 v4, 0
    s_mov_b64 exec, 1
    buffer_store_dwordx2 v[2:3], v4, s[32:35], s77 offen sc1
    s_mov_b64 exec, -1
    s_mov_b32 s75, 0
    s_cmp_ge_u32 s3, 4
    s_cbranch_scc1 f_service
    s_mov_b32 s53, 1048576
f_stg:
    ds_read_b32 v6, v255 offset:56
    s_sub_u32 s53, s53, 1
    s_cbranch_scc1 f_stg_x
    s_waitcnt lgkmcnt(0)
    v_readfirstlane_b32 s52, v6
    s_cmp_ge_u32 s52, 8
    s_cbranch_scc1 f_stg_x
    s_sleep 1
    s_branch f_stg
f_stg_x:
    v_mov_b32 v2, 1
    s_mov_b64 exec, 1
    ds_add_u32 v255, v2 offset:48
    s_mov_b64 exec, -1
    s_lshr_b32 s49, s2, 3
    s_and_b32 s50, s2, 1
    s_lshl_b32 s44, s50, 4
    s_and_b32 s51, s49, 15
    s_add_u32 s44, s44, s51
    s_and_b32 s45, s2, 6
    s_lshr_b32 s51, s49, 4
    s_add_u32 s45, s45, s51
    s_and_b32 s50, s2, 7
    s_sub_u32 s51, s50, 2
    s_lshl_b32 s51, s51, 6
    s_lshl_b32 s52, s49, 1
    s_add_u32 s47, s51, s52
    s_lshl_b32 s51, s50, 5
    s_add_u32 s51, s51, s52
    s_add_u32 s51, s51, 480
    s_cmp_eq_u32 s45, 1
    s_cselect_b32 s47, s51, s47
    s_lshl_b32 s51, s50, 6
    s_lshl_b32 s52, s49, 2
    s_add_u32 s51, s51, s52
    s_add_u32 s51, s51, 384
    s_and_b32 s95, s3, 3
    s_lshr_b32 s55, s95, 1
    s_and_b32 s56, s95, 1
    s_cmp_eq_u32 s45, 0
    s_cselect_b32 s46, 1, 0
    s_cselect_b32 s47, s51, s47
    s_cselect_b32 s55, s95, s55
    s_cselect_b32 s56, 0, s56
    s_mov_b32 s48, 0
    s_mul_i32 s6, s55, 21248
    s_sub_u32 s6, 142464, s6
    s_add_u32 s47, s47, s55
    v_and_b32 v2, 15, v1
    v_lshrrev_b32 v3, 4, v1
    v_add_u32 v4, 1, v2
    v_and_b32 v4, 3, v4
    v_add_u32 v5, 25, v2
    v_lshlrev_b32 v6, 3, v3
    v_sub_u32 v5, v5, v6
    v_sub_u32 v5, v5, v4
    v_mul_u32_u24 v4, 4160, v4
    v_lshl_add_u32 v4, v5, 1, v4
    s_lshl_b32 s50, s56, 8
    s_add_u32 s51, s50, s6
    v_add_u32 v176, s51, v4
    v_lshlrev_b32 v4, 5, v2
    v_lshl_add_u32 v4, v3, 4, v4
    s_sub_u32 s51, s6, s50
    s_add_u32 s51, s51, 16960
    v_add_u32 v177, s51, v4
    s_mov_b32 s24, s82
    s_and_b32 s25, s83, 0xffff
    s_mov_b32 s26, 1152
    s_mov_b32 s27, 0x00020000
    s_lshl_b32 s50, s47, 1
    v_mov_b32 v2, s50
    buffer_load_ushort v178, v2, s[24:27], 0 offen
    s_add_u32 s20, s4, 12582912
    s_addc_u32 s21, s5, 0
    s_and_b32 s21, s21, 0xffff
    s_mov_b32 s22, 2359296
    s_mov_b32 s23, 0x00020000
    s_branch f_conv
f_compute:
    s_mov_b32 s76, 0
    s_waitcnt lgkmcnt(0)
    s_mov_b32 s8, s66
    s_and_b32 s9, s67, 0xffff
    s_mov_b32 s10, 256
    s_mov_b32 s11, 0x00020000
    s_add_u32 s32, s4, 25165824
    s_addc_u32 s33, s5, 0
    s_and_b32 s33, s33, 0xffff
    s_mov_b32 s34, 655360
    s_mov_b32 s35, 0x00020000
    s_cmp_lg_u32 s3, 3
    s_cbranch_scc1 f_nonon
    v_and_b32 v4, 31, v1
    v_lshl_add_u32 v4, v4, 2, v255
    v_mov_b32 v5, 0
    ds_write_b32 v4, v5
    s_cmp_lg_u32 s2, 0
    s_cbranch_scc1 f_nonon
    s_or_b32 s100, s70, 1
    s_mov_b32 s101, s71
    v_mov_b32 v2, s100
    v_mov_b32 v3, s101
    v_mov_b32 v4, 0
    s_mov_b64 exec, 1
    buffer_store_dwordx2 v[2:3], v4, s[8:11], s2 offen sc1
    s_mov_b64 exec, -1
f_nonon:
    s_lshr_b32 s78, s3, 1
    s_and_b32 s79, s3, 1
    v_and_b32 v2, 31, v1
    v_lshrrev_b32 v7, 5, v1
    v_bfe_u32 v4, v1, 1, 3
    v_xor_b32 v3, v7, v4
    s_lshl_b32 s52, s78, 13
    s_add_u32 s52, s52, 32768
    v_lshl_add_u32 v2, v2, 7, s52
    v_lshl_add_u32 v16, v3, 4, v2
    v_xor_b32 v17, 32, v16
    v_xor_b32 v18, 64, v16
    v_xor_b32 v19, 96, v16
    v_bfe_u32 v3, v1, 2, 2
    v_lshl_add_u32 v2, v7, 3, v3
    v_lshlrev_b32 v2, 8, v2
    v_bfe_u32 v4, v1, 4, 1
    v_lshl_add_u32 v2, v4, 5, v2
    v_and_b32 v4, 3, v1
    v_lshl_add_u32 v2, v4, 3, v2
    v_add_u32 v2, 32768, v2
    s_lshl_b32 s52, s79, 1
    v_xor_b32 v3, s52, v3
    v_lshl_add_u32 v20, v3, 6, v2
    v_xor_b32 v21, 64, v20
    v_mov_b32 v22, v20
    v_mov_b32 v23, v21
    s_lshl_b32 s53, s44, 1
    s_add_u32 s53, s53, s78
    s_lshl_b32 s54, s53, 3
    v_lshl_add_u32 v6, v7, 1, s54
    v_mul_u32_u24 v6, 27648, v6
    s_and_b32 s54, s2, 1
    s_lshl_b32 s54, s54, 5
    s_add_u32 s53, s53, s54
    s_lshl_b32 s53, s53, 4
    s_lshl_b32 s54, s45, 1
    s_add_u32 s54, s54, s79
    s_lshl_b32 s42, s54, 1
    s_and_b32 s39, s2, 1
    s_sub_u32 s42, s42, s39
    s_add_u32 s53, s53, s54
    s_lshl_b32 s53, s53, 7
    s_add_u32 s74, s53, 131072
    s_add_u32 s53, s52, 0
    v_mov_b32 v2, s53
    s_lshl_b32 s55, s45, 2
    s_and_b32 s39, s2, 1
    s_sub_u32 s55, s55, s39
    v_add_u32 v2, s55, v2
    v_min_u32 v2, 27, v2
    v_mul_u32_u24 v3, 57, v2
    v_lshrrev_b32 v3, 9, v3
    v_mul_u32_u24 v3, 288, v3
    v_lshl_add_u32 v2, v2, 5, v3
    v_add_u32 v2, s43, v2
    v_and_b32 v3, 31, v1
    v_add_u32 v2, v2, v3
    v_cmp_gt_u32 vcc, 1728, v2
    v_lshl_add_u32 v2, v2, 4, v6
    v_bfrev_b32 v3, 1
    v_cndmask_b32 v24, v3, v2, vcc
    s_add_u32 s53, s52, 1
    v_mov_b32 v2, s53
    s_lshl_b32 s55, s45, 2
    s_and_b32 s39, s2, 1
    s_sub_u32 s55, s55, s39
    v_add_u32 v2, s55, v2
    v_min_u32 v2, 27, v2
    v_mul_u32_u24 v3, 57, v2
    v_lshrrev_b32 v3, 9, v3
    v_mul_u32_u24 v3, 288, v3
    v_lshl_add_u32 v2, v2, 5, v3
    v_add_u32 v2, s43, v2
    v_and_b32 v3, 31, v1
    v_add_u32 v2, v2, v3
    v_cmp_gt_u32 vcc, 1728, v2
    v_lshl_add_u32 v2, v2, 4, v6
    v_bfrev_b32 v3, 1
    v_cndmask_b32 v25, v3, v2, vcc
    v_mov_b64 v[32:33], 0
    v_mov_b64 v[34:35], 0
    v_mov_b64 v[36:37], 0
    v_mov_b64 v[38:39], 0
    v_mov_b64 v[40:41], 0
    v_mov_b64 v[42:43], 0
    v_mov_b64 v[44:45], 0
    v_mov_b64 v[46:47], 0
    v_mov_b64 v[48:49], 0
    v_mov_b64 v[50:51], 0
    v_mov_b64 v[52:53], 0
    v_mov_b64 v[54:55], 0
    v_mov_b64 v[56:57], 0
    v_mov_b64 v[58:59], 0
    v_mov_b64 v[60:61], 0
    v_mov_b64 v[62:63], 0
    v_mov_b64 v[64:65], 0
    v_mov_b64 v[66:67], 0
    v_mov_b64 v[68:69], 0
    v_mov_b64 v[70:71], 0
    v_mov_b64 v[72:73], 0
    v_mov_b64 v[74:75], 0
    v_mov_b64 v[76:77], 0
    v_mov_b64 v[78:79], 0
    v_mov_b64 v[80:81], 0
    v_mov_b64 v[82:83], 0
    v_mov_b64 v[84:85], 0
    v_mov_b64 v[86:87], 0
    v_mov_b64 v[88:89], 0
    v_mov_b64 v[90:91], 0
    v_mov_b64 v[92:93], 0
    v_mov_b64 v[94:95], 0
    s_add_u32 s16, s4, 0
    s_addc_u32 s17, s5, 0
    s_and_b32 s17, s17, 0xffff
    s_mov_b32 s18, 7077888
    s_mov_b32 s19, 0x00020000
    s_mul_i32 s52, s3, 28
    s_add_u32 s52, s52, s46
    s_cmp_ge_u32 s52, 36
    s_cbranch_scc1 f_nokv
    s_mul_i32 s53, s52, 57
    s_lshr_b32 s53, s53, 9
    s_add_u32 s53, s53, 1
    s_mul_i32 s53, s53, 9
    s_add_u32 s53, s53, s52
    s_lshl_b32 s53, s53, 12
    s_and_b32 s54, s2, 7
    s_mul_i32 s54, s54, 294912
    s_add_u32 s53, s53, s54
    v_lshlrev_b32 v26, 6, v1
    s_mov_b32 s12, s60
    s_and_b32 s13, s61, 0xffff
    s_mov_b32 s14, 2359296
    s_mov_b32 s15, 0x00020000
    s_mov_b32 s20, s62
    s_and_b32 s21, s63, 0xffff
    s_mov_b32 s22, 2359296
    s_mov_b32 s23, 0x00020000
    buffer_load_dword v27, v26, s[12:15], s53 offen
    buffer_load_dword v28, v26, s[20:23], s53 offen
f_nokv:
    s_cmp_lt_u32 s3, 2
    s_cbranch_scc1 f_notouch
    s_lshl_b32 s52, s2, 1
    s_add_u32 s52, s52, s3
    s_sub_u32 s52, s52, 2
    s_lshl_b32 s52, s52, 10
    v_lshlrev_b32 v26, 6, v1
    s_mov_b64 exec, 0xffff
    buffer_load_dword v27, v26, s[32:35], s52 offen sc1
    s_mov_b64 exec, -1
f_notouch:
    s_lshr_b32 s49, s2, 3
    s_and_b32 s50, s2, 1
    s_lshl_b32 s44, s50, 4
    s_and_b32 s51, s49, 15
    s_add_u32 s44, s44, s51
    s_and_b32 s45, s2, 6
    s_lshr_b32 s51, s49, 4
    s_add_u32 s45, s45, s51
    s_and_b32 s50, s2, 7
    s_sub_u32 s51, s50, 2
    s_lshl_b32 s51, s51, 6
    s_lshl_b32 s52, s49, 1
    s_add_u32 s47, s51, s52
    s_lshl_b32 s51, s50, 5
    s_add_u32 s51, s51, s52
    s_add_u32 s51, s51, 480
    s_cmp_eq_u32 s45, 1
    s_cselect_b32 s47, s51, s47
    s_lshl_b32 s51, s50, 6
    s_lshl_b32 s52, s49, 2
    s_add_u32 s51, s51, s52
    s_add_u32 s51, s51, 384
    s_and_b32 s95, s3, 3
    s_lshr_b32 s55, s95, 1
    s_and_b32 s56, s95, 1
    s_cmp_eq_u32 s45, 0
    s_cselect_b32 s46, 1, 0
    s_cselect_b32 s47, s51, s47
    s_cselect_b32 s55, s95, s55
    s_cselect_b32 s56, 0, s56
    s_mov_b32 s48, 0
    s_mul_i32 s6, s55, 21248
    s_sub_u32 s6, 142464, s6
    s_add_u32 s47, s47, s55
    v_and_b32 v2, 15, v1
    v_lshrrev_b32 v3, 4, v1
    v_add_u32 v4, 1, v2
    v_and_b32 v4, 3, v4
    v_add_u32 v5, 25, v2
    v_lshlrev_b32 v6, 3, v3
    v_sub_u32 v5, v5, v6
    v_sub_u32 v5, v5, v4
    v_mul_u32_u24 v4, 4160, v4
    v_lshl_add_u32 v4, v5, 1, v4
    s_lshl_b32 s50, s56, 8
    s_add_u32 s51, s50, s6
    v_add_u32 v176, s51, v4
    v_lshlrev_b32 v4, 5, v2
    v_lshl_add_u32 v4, v3, 4, v4
    s_sub_u32 s51, s6, s50
    s_add_u32 s51, s51, 16960
    v_add_u32 v177, s51, v4
    s_mov_b32 s24, s82
    s_and_b32 s25, s83, 0xffff
    s_mov_b32 s26, 1152
    s_mov_b32 s27, 0x00020000
    s_lshl_b32 s50, s47, 1
    v_mov_b32 v2, s50
    buffer_load_ushort v178, v2, s[24:27], 0 offen
    s_add_u32 s20, s4, 12582912
    s_addc_u32 s21, s5, 0
    s_and_b32 s21, s21, 0xffff
    s_mov_b32 s22, 2359296
    s_mov_b32 s23, 0x00020000
    s_mov_b32 s41, 0
    s_waitcnt lgkmcnt(0)
    s_barrier
    ds_read_b128 v[96:99], v16 offset:0
    ds_read_b128 v[100:103], v16 offset:4096
    ds_read_b64_tr_b16 v[104:105], v20 offset:16384
    ds_read_b64_tr_b16 v[106:107], v20 offset:17408
    ds_read_b64_tr_b16 v[108:109], v21 offset:16384
    ds_read_b64_tr_b16 v[110:111], v21 offset:17408
    ds_read_b128 v[112:115], v17 offset:0
    ds_read_b128 v[116:119], v17 offset:4096
    ds_read_b64_tr_b16 v[120:121], v20 offset:20480
    ds_read_b64_tr_b16 v[122:123], v20 offset:21504
    ds_read_b64_tr_b16 v[124:125], v21 offset:20480
    ds_read_b64_tr_b16 v[126:127], v21 offset:21504
f_cloop:
    s_and_b32 s50, s41, 3
    s_cmp_eq_u32 s50, 2
    s_mov_b32 s40, 32768
    s_cselect_b32 s40, 4294868992, s40
    s_waitcnt lgkmcnt(6)
    v_mfma_f32_32x32x16_bf16 v[32:47], v[96:99], v[104:107], v[32:47]
    ds_read_b128 v[128:131], v18 offset:0
    ds_read_b128 v[132:135], v18 offset:4096
    ds_read_b64_tr_b16 v[136:137], v22 offset:24576
    v_mfma_f32_32x32x16_bf16 v[48:63], v[96:99], v[108:111], v[48:63]
    ds_read_b64_tr_b16 v[138:139], v22 offset:25600
    ds_read_b64_tr_b16 v[140:141], v23 offset:24576
    ds_read_b64_tr_b16 v[142:143], v23 offset:25600
    v_mfma_f32_32x32x16_bf16 v[64:79], v[100:103], v[104:107], v[64:79]
    v_add_u32 v16, s40, v16
    v_add_u32 v17, s40, v17
    v_add_u32 v20, s40, v20
    v_add_u32 v21, s40, v21
    v_mfma_f32_32x32x16_bf16 v[80:95], v[100:103], v[108:111], v[80:95]
    s_waitcnt lgkmcnt(6)
    v_mfma_f32_32x32x16_bf16 v[32:47], v[112:115], v[120:123], v[32:47]
    ds_read_b128 v[144:147], v19 offset:0
    ds_read_b128 v[148:151], v19 offset:4096
    ds_read_b64_tr_b16 v[152:153], v22 offset:28672
    v_mfma_f32_32x32x16_bf16 v[48:63], v[112:115], v[124:127], v[48:63]
    ds_read_b64_tr_b16 v[154:155], v22 offset:29696
    ds_read_b64_tr_b16 v[156:157], v23 offset:28672
    ds_read_b64_tr_b16 v[158:159], v23 offset:29696
    v_mfma_f32_32x32x16_bf16 v[64:79], v[116:119], v[120:123], v[64:79]
    v_mfma_f32_32x32x16_bf16 v[80:95], v[116:119], v[124:127], v[80:95]
    s_waitcnt lgkmcnt(6)
    v_mfma_f32_32x32x16_bf16 v[32:47], v[128:131], v[136:139], v[32:47]
    s_cmp_eq_u32 s41, 8
    s_cbranch_scc1 f_nobar
    s_barrier
    f_nobar:
    ds_read_b128 v[96:99], v16 offset:0
    ds_read_b128 v[100:103], v16 offset:4096
    v_mfma_f32_32x32x16_bf16 v[48:63], v[128:131], v[140:143], v[48:63]
    ds_read_b64_tr_b16 v[104:105], v20 offset:16384
    ds_read_b64_tr_b16 v[106:107], v20 offset:17408
    ds_read_b64_tr_b16 v[108:109], v21 offset:16384
    v_mfma_f32_32x32x16_bf16 v[64:79], v[132:135], v[136:139], v[64:79]
    ds_read_b64_tr_b16 v[110:111], v21 offset:17408
    v_add_u32 v18, s40, v18
    v_add_u32 v19, s40, v19
    v_add_u32 v22, s40, v22
    v_add_u32 v23, s40, v23
    v_mfma_f32_32x32x16_bf16 v[80:95], v[132:135], v[140:143], v[80:95]
    s_waitcnt lgkmcnt(6)
    v_mfma_f32_32x32x16_bf16 v[32:47], v[144:147], v[152:155], v[32:47]
    ds_read_b128 v[112:115], v17 offset:0
    ds_read_b128 v[116:119], v17 offset:4096
    ds_read_b64_tr_b16 v[120:121], v20 offset:20480
    v_mfma_f32_32x32x16_bf16 v[48:63], v[144:147], v[156:159], v[48:63]
    ds_read_b64_tr_b16 v[122:123], v20 offset:21504
    ds_read_b64_tr_b16 v[124:125], v21 offset:20480
    ds_read_b64_tr_b16 v[126:127], v21 offset:21504
    v_mfma_f32_32x32x16_bf16 v[64:79], v[148:151], v[152:155], v[64:79]
    v_mfma_f32_32x32x16_bf16 v[80:95], v[148:151], v[156:159], v[80:95]
    s_add_u32 s41, s41, 1
    s_cmp_lt_u32 s41, 9
    s_cbranch_scc1 f_cloop
    s_waitcnt lgkmcnt(0)
    v_mov_b32 v2, 1
    s_mov_b64 exec, 1
    ds_add_u32 v255, v2 offset:48
    s_mov_b64 exec, -1
    s_mov_b32 s40, 0x3eae1a93
    s_mov_b32 s41, s40
    s_nop 3
    s_cmp_ge_i32 s42, 9
    s_cbranch_scc1 f_noscale
    v_pk_mul_f32 v[32:33], v[32:33], s[40:41]
    v_pk_mul_f32 v[34:35], v[34:35], s[40:41]
    v_pk_mul_f32 v[36:37], v[36:37], s[40:41]
    v_pk_mul_f32 v[38:39], v[38:39], s[40:41]
    v_pk_mul_f32 v[40:41], v[40:41], s[40:41]
    v_pk_mul_f32 v[42:43], v[42:43], s[40:41]
    v_pk_mul_f32 v[44:45], v[44:45], s[40:41]
    v_pk_mul_f32 v[46:47], v[46:47], s[40:41]
    v_pk_mul_f32 v[64:65], v[64:65], s[40:41]
    v_pk_mul_f32 v[66:67], v[66:67], s[40:41]
    v_pk_mul_f32 v[68:69], v[68:69], s[40:41]
    v_pk_mul_f32 v[70:71], v[70:71], s[40:41]
    v_pk_mul_f32 v[72:73], v[72:73], s[40:41]
    v_pk_mul_f32 v[74:75], v[74:75], s[40:41]
    v_pk_mul_f32 v[76:77], v[76:77], s[40:41]
    v_pk_mul_f32 v[78:79], v[78:79], s[40:41]
    s_cmp_ge_i32 s42, 8
    s_cbranch_scc1 f_noscale
    v_pk_mul_f32 v[48:49], v[48:49], s[40:41]
    v_pk_mul_f32 v[50:51], v[50:51], s[40:41]
    v_pk_mul_f32 v[52:53], v[52:53], s[40:41]
    v_pk_mul_f32 v[54:55], v[54:55], s[40:41]
    v_pk_mul_f32 v[56:57], v[56:57], s[40:41]
    v_pk_mul_f32 v[58:59], v[58:59], s[40:41]
    v_pk_mul_f32 v[60:61], v[60:61], s[40:41]
    v_pk_mul_f32 v[62:63], v[62:63], s[40:41]
    v_pk_mul_f32 v[80:81], v[80:81], s[40:41]
    v_pk_mul_f32 v[82:83], v[82:83], s[40:41]
    v_pk_mul_f32 v[84:85], v[84:85], s[40:41]
    v_pk_mul_f32 v[86:87], v[86:87], s[40:41]
    v_pk_mul_f32 v[88:89], v[88:89], s[40:41]
    v_pk_mul_f32 v[90:91], v[90:91], s[40:41]
    v_pk_mul_f32 v[92:93], v[92:93], s[40:41]
    v_pk_mul_f32 v[94:95], v[94:95], s[40:41]
f_noscale:
    v_cvt_pk_bf16_f32 v96, v32, v33
    v_cvt_pk_bf16_f32 v97, v34, v35
    v_cvt_pk_bf16_f32 v98, v36, v37
    v_cvt_pk_bf16_f32 v99, v38, v39
    s_mov_b32 s50, 0
    buffer_store_dwordx4 v[96:99], v24, s[16:19], s50 offen sc1
    v_cvt_pk_bf16_f32 v100, v40, v41
    v_cvt_pk_bf16_f32 v101, v42, v43
    v_cvt_pk_bf16_f32 v102, v44, v45
    v_cvt_pk_bf16_f32 v103, v46, v47
    s_mov_b32 s50, 27648
    buffer_store_dwordx4 v[100:103], v24, s[16:19], s50 offen sc1
    v_cvt_pk_bf16_f32 v104, v48, v49
    v_cvt_pk_bf16_f32 v105, v50, v51
    v_cvt_pk_bf16_f32 v106, v52, v53
    v_cvt_pk_bf16_f32 v107, v54, v55
    s_mov_b32 s50, 0
    buffer_store_dwordx4 v[104:107], v25, s[16:19], s50 offen sc1
    v_cvt_pk_bf16_f32 v108, v56, v57
    v_cvt_pk_bf16_f32 v109, v58, v59
    v_cvt_pk_bf16_f32 v110, v60, v61
    v_cvt_pk_bf16_f32 v111, v62, v63
    s_mov_b32 s50, 27648
    buffer_store_dwordx4 v[108:111], v25, s[16:19], s50 offen sc1
    v_cvt_pk_bf16_f32 v112, v64, v65
    v_cvt_pk_bf16_f32 v113, v66, v67
    v_cvt_pk_bf16_f32 v114, v68, v69
    v_cvt_pk_bf16_f32 v115, v70, v71
    s_mov_b32 s50, 110592
    buffer_store_dwordx4 v[112:115], v24, s[16:19], s50 offen sc1
    v_cvt_pk_bf16_f32 v116, v72, v73
    v_cvt_pk_bf16_f32 v117, v74, v75
    v_cvt_pk_bf16_f32 v118, v76, v77
    v_cvt_pk_bf16_f32 v119, v78, v79
    s_mov_b32 s50, 138240
    buffer_store_dwordx4 v[116:119], v24, s[16:19], s50 offen sc1
    v_cvt_pk_bf16_f32 v120, v80, v81
    v_cvt_pk_bf16_f32 v121, v82, v83
    v_cvt_pk_bf16_f32 v122, v84, v85
    v_cvt_pk_bf16_f32 v123, v86, v87
    s_mov_b32 s50, 110592
    buffer_store_dwordx4 v[120:123], v25, s[16:19], s50 offen sc1
    v_cvt_pk_bf16_f32 v124, v88, v89
    v_cvt_pk_bf16_f32 v125, v90, v91
    v_cvt_pk_bf16_f32 v126, v92, v93
    v_cvt_pk_bf16_f32 v127, v94, v95
    s_mov_b32 s50, 138240
    buffer_store_dwordx4 v[124:127], v25, s[16:19], s50 offen sc1
    s_mov_b32 s94, 1048576
f_ln_3:
    ds_read_b64 v[4:5], v255 offset:40
    s_sub_u32 s94, s94, 1
    s_cbranch_scc1 f_ln_3_x
    s_waitcnt lgkmcnt(0)
    v_readfirstlane_b32 s100, v4
    v_readfirstlane_b32 s101, v5
    s_cmp_eq_u32 s100, 0
    s_cbranch_scc1 f_ln_3
f_ln_3_x:
    s_mov_b32 s59, s74
    s_branch k2_setup
f_service:
    s_lshr_b32 s49, s2, 3
    s_and_b32 s50, s2, 1
    s_lshl_b32 s44, s50, 4
    s_and_b32 s51, s49, 15
    s_add_u32 s44, s44, s51
    s_and_b32 s45, s2, 6
    s_lshr_b32 s51, s49, 4
    s_add_u32 s45, s45, s51
    s_and_b32 s50, s2, 7
    s_sub_u32 s51, s50, 2
    s_lshl_b32 s51, s51, 6
    s_lshl_b32 s52, s49, 1
    s_add_u32 s47, s51, s52
    s_lshl_b32 s51, s50, 5
    s_add_u32 s51, s51, s52
    s_add_u32 s51, s51, 480
    s_cmp_eq_u32 s45, 1
    s_cselect_b32 s47, s51, s47
    s_lshl_b32 s51, s50, 6
    s_lshl_b32 s52, s49, 2
    s_add_u32 s51, s51, s52
    s_add_u32 s51, s51, 384
    s_and_b32 s95, s3, 3
    s_lshr_b32 s55, s95, 1
    s_and_b32 s56, s95, 1
    s_cmp_eq_u32 s45, 0
    s_cselect_b32 s46, 1, 0
    s_cselect_b32 s47, s51, s47
    s_cselect_b32 s55, s95, s55
    s_cselect_b32 s56, 0, s56
    s_mov_b32 s48, 0
    s_mul_i32 s6, s55, 21248
    s_sub_u32 s6, 142464, s6
    s_add_u32 s47, s47, s55
    v_lshrrev_b32 v2, 3, v1
    v_and_b32 v3, 7, v1
    v_lshlrev_b32 v2, 9, v2
    v_lshl_add_u32 v2, v3, 4, v2
    s_lshl_b32 s51, s56, 8
    s_add_u32 s52, s6, s51
    v_add_u32 v26, s52, v2
    s_lshl_b32 s50, s47, 12
    s_add_u32 s51, s51, s50
    v_add_u32 v24, s51, v2
    v_subrev_u32 v25, 32, v24
    s_mov_b32 s98, 0x03030303
    s_mov_b32 s99, 0x03030303
    s_mov_b32 s16, s80
    s_and_b32 s17, s81, 0xffff
    s_mov_b32 s18, 2359296
    s_mov_b32 s19, 0x00020000
    s_add_u32 s32, s4, 25165824
    s_addc_u32 s33, s5, 0
    s_and_b32 s33, s33, 0xffff
    s_mov_b32 s34, 655360
    s_mov_b32 s35, 0x00020000
    s_lshr_b32 s50, s47, 6
    s_lshl_b32 s50, s50, 13
    v_lshl_add_u32 v20, v1, 7, s50
    s_mov_b32 s28, s86
    s_and_b32 s29, s87, 0xffff
    s_mov_b32 s30, 2359296
    s_mov_b32 s31, 0x00020000
    s_mov_b32 s40, s84
    s_and_b32 s41, s85, 0xffff
    s_mov_b32 s42, 1152
    s_mov_b32 s43, 0x00020000
    s_mov_b32 s36, s88
    s_and_b32 s37, s89, 0xffff
    s_mov_b32 s38, 663552
    s_mov_b32 s39, 0x00020000
    s_lshl_b32 s50, s45, 5
    s_add_u32 s50, s50, s44
    s_lshl_b32 s50, s50, 2
    s_add_u32 s50, s50, s95
    s_lshl_b32 s7, s50, 1
    s_mul_i32 s53, s7, 1152
    v_lshlrev_b32 v27, 4, v1
    s_lshl_b32 s50, s49, 2
    s_add_u32 s50, s50, s95
    s_lshl_b32 s50, s50, 6
    v_add_u32 v8, s50, v1
    v_mul_u32_u24 v9, 6554, v8
    v_lshrrev_b32 v9, 16, v9
    v_lshlrev_b32 v9, 9, v9
    v_lshl_add_u32 v19, v8, 6, v9
    s_and_b32 s50, s2, 1
    s_mul_i32 s54, s50, 576
    s_cmp_eq_u32 s75, 1
    s_cbranch_scc1 f_ldloop
f_service2:
    buffer_load_dwordx4 v[224:227], v27, s[28:31], s53 offen offset:0
    buffer_load_dwordx4 v[228:231], v27, s[28:31], s53 offen offset:1024
    buffer_load_dwordx4 v[232:235], v27, s[28:31], s53 offen offset:1152
    buffer_load_dwordx4 v[236:239], v27, s[28:31], s53 offen offset:2176
    buffer_load_dwordx4 v[240:243], v27, s[40:43], 0 offen
    buffer_load_dwordx4 v[244:247], v27, s[40:43], 0 offen offset:1024
    buffer_load_dword v248, v19, s[36:39], s54 offen
    buffer_load_dwordx4 v[32:35], v25, s[16:19], 0 offen offset:0
    buffer_load_dwordx2 v[36:37], v25, s[16:19], 0 offen offset:16
    buffer_load_dwordx4 v[38:41], v24, s[16:19], 0 offen offset:96
    buffer_load_dwordx2 v[42:43], v24, s[16:19], 0 offen offset:112
    s_mov_b64 exec, s[98:99]
    buffer_load_dwordx4 v[44:47], v24, s[16:19], 0 offen offset:224
    buffer_load_dwordx2 v[48:49], v24, s[16:19], 0 offen offset:240
    s_mov_b64 exec, -1
    s_cmp_eq_u32 s75, 0
    s_cbranch_scc1 f_h1
    s_waitcnt vmcnt(21)
    s_barrier
    s_waitcnt vmcnt(13)
    s_barrier
    s_cmp_eq_u32 s46, 0
    s_cbranch_scc1 f_h1
    buffer_load_dwordx4 v[50:53], v24, s[16:19], 0 offen offset:224
    buffer_load_dwordx2 v[54:55], v24, s[16:19], 0 offen offset:240
    buffer_load_dwordx4 v[56:59], v24, s[16:19], 0 offen offset:352
    buffer_load_dwordx2 v[60:61], v24, s[16:19], 0 offen offset:368
    s_mov_b64 exec, s[98:99]
    buffer_load_dwordx4 v[62:65], v24, s[16:19], 0 offen offset:480
    buffer_load_dwordx2 v[66:67], v24, s[16:19], 0 offen offset:496
    s_mov_b64 exec, -1
f_h1:
    s_setprio 1
    s_cmp_lg_u32 s3, 7
    s_cbranch_scc1 f_non4
    ds_read_b32 v2, v255 offset:40
    s_waitcnt lgkmcnt(0)
    v_cmp_ne_u32 vcc, 0, v2
    s_cbranch_vccnz f_non4
    s_load_dwordx2 s[96:97], s[0:1], 88
    s_waitcnt lgkmcnt(0)
    s_mov_b32 s12, s96
    s_and_b32 s13, s97, 0xffff
    s_mov_b32 s14, 256
    s_mov_b32 s15, 0x00020000
    v_mov_b32 v2, 0
    s_mov_b32 s50, 65536
f_non2:
    buffer_load_dwordx2 v[4:5], v2, s[12:15], 0 offen sc1
    s_sub_u32 s50, s50, 1
    s_cbranch_scc1 f_non2_x
    s_waitcnt vmcnt(0)
    v_cmp_ne_u32 vcc, 0, v4
    s_cbranch_vccnz f_non2_x
    s_sleep 4
    s_branch f_non2
f_non2_x:
    ds_write_b64 v255, v[4:5] offset:40
    s_waitcnt lgkmcnt(0)
f_non4:
    s_mov_b32 s94, 1048576
f_ln_4:
    ds_read_b64 v[4:5], v255 offset:40
    s_sub_u32 s94, s94, 1
    s_cbranch_scc1 f_ln_4_x
    s_waitcnt lgkmcnt(0)
    v_readfirstlane_b32 s100, v4
    v_readfirstlane_b32 s101, v5
    s_cmp_eq_u32 s100, 0
    s_cbranch_scc1 f_ln_4
f_ln_4_x:
    s_add_u32 s12, s4, 8388608
    s_addc_u32 s13, s5, 0
    s_and_b32 s13, s13, 0xffff
    s_mov_b32 s14, 2359296
    s_mov_b32 s15, 0x00020000
    s_waitcnt vmcnt(0)
f_build:
    v_alignbit_b32 v80, v33, v32, 16
    v_alignbit_b32 v84, v34, v33, 16
    v_mov_b32 v88, v33
    v_alignbit_b32 v81, v34, v33, 16
    v_alignbit_b32 v85, v35, v34, 16
    v_mov_b32 v89, v34
    v_alignbit_b32 v82, v35, v34, 16
    v_alignbit_b32 v86, v36, v35, 16
    v_mov_b32 v90, v35
    v_alignbit_b32 v83, v36, v35, 16
    v_alignbit_b32 v87, v37, v36, 16
    v_mov_b32 v91, v36
    ds_write_b128 v26, v[32:35] offset:0
    ds_write_b128 v26, v[80:83] offset:4160
    ds_write_b128 v26, v[88:91] offset:8320
    ds_write_b128 v26, v[84:87] offset:12480
    v_alignbit_b32 v92, v39, v38, 16
    v_alignbit_b32 v96, v40, v39, 16
    v_mov_b32 v100, v39
    v_alignbit_b32 v93, v40, v39, 16
    v_alignbit_b32 v97, v41, v40, 16
    v_mov_b32 v101, v40
    v_alignbit_b32 v94, v41, v40, 16
    v_alignbit_b32 v98, v42, v41, 16
    v_mov_b32 v102, v41
    v_alignbit_b32 v95, v42, v41, 16
    v_alignbit_b32 v99, v43, v42, 16
    v_mov_b32 v103, v42
    ds_write_b128 v26, v[38:41] offset:128
    ds_write_b128 v26, v[92:95] offset:4288
    ds_write_b128 v26, v[100:103] offset:8448
    ds_write_b128 v26, v[96:99] offset:12608
    v_alignbit_b32 v104, v45, v44, 16
    v_alignbit_b32 v108, v46, v45, 16
    v_mov_b32 v112, v45
    v_alignbit_b32 v105, v46, v45, 16
    v_alignbit_b32 v109, v47, v46, 16
    v_mov_b32 v113, v46
    v_alignbit_b32 v106, v47, v46, 16
    v_alignbit_b32 v110, v48, v47, 16
    v_mov_b32 v114, v47
    v_alignbit_b32 v107, v48, v47, 16
    v_alignbit_b32 v111, v49, v48, 16
    v_mov_b32 v115, v48
    s_mov_b64 exec, s[98:99]
    ds_write_b128 v26, v[44:47] offset:256
    ds_write_b128 v26, v[104:107] offset:4416
    ds_write_b128 v26, v[112:115] offset:8576
    ds_write_b128 v26, v[108:111] offset:12736
    s_mov_b64 exec, -1
    s_cmp_lg_u32 s56, 0
    s_cbranch_scc1 f_built
    v_mov_b64 v[28:29], 0
    v_mov_b64 v[30:31], 0
    v_lshl_add_u32 v3, v1, 4, s6
    s_mov_b64 exec, 0x3fffffff
    ds_write_b128 v3, v[28:31] offset:16640
    s_mov_b64 exec, 3
    ds_write_b128 v26, v[28:31] offset:0
    ds_write_b128 v26, v[28:31] offset:4160
    ds_write_b128 v26, v[28:31] offset:8320
    ds_write_b128 v26, v[28:31] offset:12480
    s_mov_b64 exec, 4
    v_lshlrev_b32 v4, 16, v32
    ds_write_b32 v26, v4 offset:4156
    ds_write_b32 v26, v32 offset:8316
    ds_write_b32 v26, v4 offset:12472
    ds_write_b32 v26, v80 offset:12476
    s_mov_b64 exec, -1
    s_cmp_eq_u32 s46, 0
    s_cbranch_scc1 f_built
    s_waitcnt lgkmcnt(0)
    v_mov_b64 v[32:33], v[50:51]
    v_mov_b64 v[34:35], v[52:53]
    v_mov_b64 v[36:37], v[54:55]
    v_mov_b64 v[38:39], v[56:57]
    v_mov_b64 v[40:41], v[58:59]
    v_mov_b64 v[42:43], v[60:61]
    v_mov_b64 v[44:45], v[62:63]
    v_mov_b64 v[46:47], v[64:65]
    v_mov_b64 v[48:49], v[66:67]
    v_add_u32 v26, 256, v26
    s_mov_b32 s56, 1
    s_branch f_build
f_built:
    s_lshl_b32 s50, s55, 2
    v_add_u32 v2, s50, v255
    v_mov_b32 v29, v2
    s_add_u32 s51, s46, 1
    s_waitcnt vmcnt(0) lgkmcnt(0)
    v_mov_b32 v3, s51
    s_mov_b64 exec, 1
    ds_add_u32 v2, v3 offset:16
    s_mov_b64 exec, -1
k2_setup:
    s_add_u32 s24, s4, 16777216
    s_addc_u32 s25, s5, 0
    s_and_b32 s25, s25, 0xffff
    s_mov_b32 s26, 2359296
    s_mov_b32 s27, 0x00020000
    v_bfe_u32 v2, v1, 4, 1
    s_lshl_b32 s50, s48, 2
    v_lshl_add_u32 v8, v2, 1, s50
    v_and_b32 v7, 1, v1
    v_bfe_u32 v9, v1, 1, 1
    v_add_u32 v2, v8, v7
    v_mul_u32_u24 v2, 576, v2
    v_lshl_add_u32 v2, v9, 3, v2
    v_bfe_u32 v3, v1, 2, 2
    v_lshrrev_b32 v4, 5, v1
    v_lshl_add_u32 v5, v4, 3, v3
    v_lshl_add_u32 v204, v5, 4, v2
    v_and_or_b32 v6, v3, 1, 16
    v_lshl_add_u32 v205, v6, 4, v2
    v_add_u32 v2, v8, v9
    v_mul_u32_u24 v2, 288, v2
    v_lshl_add_u32 v2, v7, 3, v2
    v_lshl_add_u32 v207, v5, 4, v2
    v_lshl_add_u32 v208, v6, 4, v2
    v_and_b32 v2, 0x13, v1
    v_bfe_u32 v3, v1, 2, 1
    v_lshl_or_b32 v2, v3, 3, v2
    v_bfe_u32 v3, v1, 3, 1
    v_lshl_or_b32 v2, v3, 2, v2
    v_add_u32 v3, s50, v4
    v_mul_u32_u24 v3, 576, v3
    v_lshl_add_u32 v206, v2, 4, v3
    s_lshl_b32 s50, s45, 8
    s_lshl_b32 s51, s48, 5
    s_add_u32 s50, s50, s51
    v_and_b32 v2, 31, v1
    v_add_lshl_u32 v211, v2, s50, 4
    v_lshl_add_u32 v210, v4, 15, v211
    v_lshlrev_b32 v3, 3, v4
    v_sub_u32 v3, v2, v3
    v_cmp_le_i32 s[60:61], 0, v3
    v_cmp_le_i32 s[62:63], 1, v3
    v_cmp_le_i32 s[64:65], 2, v3
    v_cmp_le_i32 s[66:67], 3, v3
    v_cmp_le_i32 s[68:69], 4, v3
    v_cmp_le_i32 s[70:71], 5, v3
    v_cmp_le_i32 s[72:73], 6, v3
    v_cmp_le_i32 s[74:75], 7, v3
    v_cmp_le_i32 s[76:77], 16, v3
    v_cmp_le_i32 s[78:79], 17, v3
    v_cmp_le_i32 s[80:81], 18, v3
    v_cmp_le_i32 s[82:83], 19, v3
    v_cmp_le_i32 s[84:85], 20, v3
    v_cmp_le_i32 s[86:87], 21, v3
    v_cmp_le_i32 s[88:89], 22, v3
    v_cmp_le_i32 s[90:91], 23, v3
    v_cmp_gt_u32 s[92:93], 18, v2
    v_and_b32 v2, 27, v2
    v_cmp_eq_u32 vcc, 18, v2
    v_mov_b32 v2, 0x3f803f80
    v_mov_b32 v3, 0xffff
    v_cndmask_b32 v180, 0, v2, vcc
    v_cmp_gt_u32 vcc, 32, v1
    v_mov_b32 v181, v180
    v_mov_b64 v[182:183], v[180:181]
    v_mov_b64 v[184:185], v[180:181]
    v_mov_b64 v[186:187], v[180:181]
    v_mov_b64 v[188:189], v[180:181]
    v_mov_b64 v[190:191], v[180:181]
    v_mov_b64 v[192:193], v[180:181]
    v_mov_b64 v[194:195], v[180:181]
    v_cndmask_b32 v209, 0, v2, vcc
    v_cndmask_b32 v5, 0, v3, s[60:61]
    v_cndmask_b32 v196, v5, -1, s[62:63]
    v_cndmask_b32 v5, 0, v3, s[64:65]
    v_cndmask_b32 v197, v5, -1, s[66:67]
    v_cndmask_b32 v5, 0, v3, s[68:69]
    v_cndmask_b32 v198, v5, -1, s[70:71]
    v_cndmask_b32 v5, 0, v3, s[72:73]
    v_cndmask_b32 v199, v5, -1, s[74:75]
    v_cndmask_b32 v5, 0, v3, s[76:77]
    v_cndmask_b32 v200, v5, -1, s[78:79]
    v_cndmask_b32 v5, 0, v3, s[80:81]
    v_cndmask_b32 v201, v5, -1, s[82:83]
    v_cndmask_b32 v5, 0, v3, s[84:85]
    v_cndmask_b32 v202, v5, -1, s[86:87]
    v_cndmask_b32 v5, 0, v3, s[88:89]
    v_cndmask_b32 v203, v5, -1, s[90:91]
    s_cmp_lt_u32 s3, 4
    s_cbranch_scc1 f_conv2
    s_mov_b32 s59, 0
    s_mul_i32 s50, s45, 55296
    s_mul_i32 s51, s44, 18
    s_add_u32 s54, s50, s51
    s_add_u32 s53, s54, 576
    v_mov_b32 v6, 558
    s_lshl_b32 s50, s95, 6
    v_add_u32 v3, s50, v1
    v_mul_u32_u24 v4, 1821, v3
    v_lshrrev_b32 v4, 16, v4
    v_mul_u32_u24 v5, 36, v4
    v_sub_u32 v5, v3, v5
    v_cmp_lt_u32 vcc, 17, v5
    v_mul_u32_u24 v4, 1692, v4
    v_add3_u32 v3, v3, v4, s53
    v_cndmask_b32 v5, 0, v6, vcc
    v_add_lshl_u32 v120, v3, v5, 4
    v_subrev_u32 v121, 884736, v120
    v_add_u32 v3, s50, v1
    v_add_u32 v3, 256, v3
    v_mul_u32_u24 v4, 1821, v3
    v_lshrrev_b32 v4, 16, v4
    v_mul_u32_u24 v5, 36, v4
    v_sub_u32 v5, v3, v5
    v_cmp_lt_u32 vcc, 17, v5
    v_mul_u32_u24 v4, 1692, v4
    v_add3_u32 v3, v3, v4, s53
    v_cndmask_b32 v5, 0, v6, vcc
    v_add_lshl_u32 v122, v3, v5, 4
    v_subrev_u32 v123, 884736, v122
    v_add_u32 v3, 512, v1
    v_mul_u32_u24 v4, 1821, v3
    v_lshrrev_b32 v4, 16, v4
    v_mul_u32_u24 v5, 36, v4
    v_sub_u32 v5, v3, v5
    v_cmp_lt_u32 vcc, 17, v5
    v_mul_u32_u24 v4, 1692, v4
    v_add3_u32 v3, v3, v4, s53
    v_cndmask_b32 v5, 0, v6, vcc
    v_add_lshl_u32 v124, v3, v5, 4
    v_subrev_u32 v125, 884736, v124
    s_mul_i32 s50, s95, 192
    s_sub_u32 s50, s50, 192
    s_max_i32 s50, s50, 0
    v_add_u32 v3, s50, v1
    v_mul_u32_u24 v4, 3641, v3
    v_lshrrev_b32 v4, 16, v4
    v_mul_u32_u24 v4, 1710, v4
    v_add3_u32 v3, v3, v4, s54
    v_lshlrev_b32 v126, 4, v3
    v_add_u32 v3, s50, v1
    v_add_u32 v3, 64, v3
    v_mul_u32_u24 v4, 3641, v3
    v_lshrrev_b32 v4, 16, v4
    v_mul_u32_u24 v4, 1710, v4
    v_add3_u32 v3, v3, v4, s54
    v_lshlrev_b32 v127, 4, v3
    v_add_u32 v3, s50, v1
    v_add_u32 v3, 128, v3
    v_mul_u32_u24 v4, 3641, v3
    v_lshrrev_b32 v4, 16, v4
    v_mul_u32_u24 v4, 1710, v4
    v_add3_u32 v3, v3, v4, s54
    v_lshlrev_b32 v128, 4, v3
    s_add_u32 s36, s4, 25264128
    s_addc_u32 s37, s5, 0
    s_and_b32 s37, s37, 0xffff
    s_mov_b32 s38, 16384
    s_mov_b32 s39, 0x00020000
    s_add_u32 s8, s4, 0
    s_addc_u32 s9, s5, 0
    s_and_b32 s9, s9, 0xffff
    s_mov_b32 s10, 7077888
    s_mov_b32 s11, 0x00020000
    v_dot2_f32_bf16 v6, v224, v240, 0
    v_dot2_f32_bf16 v6, v225, v241, v6
    v_dot2_f32_bf16 v6, v226, v242, v6
    v_dot2_f32_bf16 v6, v227, v243, v6
    v_dot2_f32_bf16 v6, v228, v244, v6
    v_dot2_f32_bf16 v6, v229, v245, v6
    v_dot2_f32_bf16 v6, v230, v246, v6
    v_dot2_f32_bf16 v6, v231, v247, v6
    v_dot2_f32_bf16 v8, v232, v240, 0
    v_dot2_f32_bf16 v8, v233, v241, v8
    v_dot2_f32_bf16 v8, v234, v242, v8
    v_dot2_f32_bf16 v8, v235, v243, v8
    v_dot2_f32_bf16 v8, v236, v244, v8
    v_dot2_f32_bf16 v8, v237, v245, v8
    v_dot2_f32_bf16 v8, v238, v246, v8
    v_dot2_f32_bf16 v8, v239, v247, v8
    s_nop 2
    v_permlane32_swap_b32 v6, v8
    s_nop 0
    v_add_f32 v6, v6, v8
    s_nop 1
    v_add_f32_dpp v6, v6, v6 quad_perm:[1,0,3,2] row_mask:0xf bank_mask:0xf
    s_nop 1
    v_add_f32_dpp v6, v6, v6 quad_perm:[2,3,0,1] row_mask:0xf bank_mask:0xf
    s_nop 1
    v_add_f32_dpp v6, v6, v6 row_half_mirror row_mask:0xf bank_mask:0xf
    s_nop 1
    v_add_f32_dpp v6, v6, v6 row_mirror row_mask:0xf bank_mask:0xf
    v_mov_b32 v7, v6
    s_nop 1
    v_permlane16_swap_b32 v6, v7
    s_nop 0
    v_add_f32 v6, v6, v7
    v_cvt_pk_bf16_f32 v6, v6, v6
    v_lshlrev_b32 v6, 16, v6
    v_mul_f32 v6, 0xbfb8aa3b, v6
    v_exp_f32 v6, v6
    s_lshl_b32 s50, s7, 3
    v_add_f32 v6, 1.0, v6
    v_rcp_f32 v6, v6
    v_lshrrev_b32 v8, 2, v1
    v_cvt_pk_bf16_f32 v6, v6, v6
    v_lshlrev_b32 v6, 16, v6
    v_mov_b32 v7, s100
    s_mov_b32 exec_lo, 1
    s_mov_b32 exec_hi, 1
    buffer_store_dwordx2 v[6:7], v8, s[36:39], s50 offen sc1
    s_mov_b64 exec, -1
    s_mov_b32 s51, 1048576
f_free3:
    ds_read_b32 v6, v255 offset:48
    s_sub_u32 s51, s51, 1
    s_cbranch_scc1 f_free3_x
    s_waitcnt lgkmcnt(0)
    v_readfirstlane_b32 s50, v6
    s_cmp_ge_u32 s50, 4
    s_cbranch_scc1 f_free3_x
    s_sleep 2
    s_branch f_free3
f_free3_x:
    s_cmp_eq_u32 s46, 1
    s_cbranch_scc1 f_wex
    s_load_dwordx2 s[42:43], s[0:1], 16
    s_and_b32 s50, s2, 6
    s_lshl_b32 s16, s50, 8
    s_lshr_b32 s50, s2, 5
    s_lshl_b32 s50, s50, 6
    s_add_u32 s16, s16, s50
    s_and_b32 s50, s2, 1
    s_lshl_b32 s17, s50, 2
    s_bfe_u32 s50, s2, 0x20003
    s_add_u32 s17, s17, s50
    s_mul_i32 s53, s17, 144
    s_mul_i32 s50, s95, 41472
    s_mul_i32 s51, s95, 5120
    s_add_u32 s51, s51, 46080
    s_add_u32 s52, s50, 165888
    v_mov_b32 v5, v1
    s_mov_b32 s18, 0
    s_waitcnt lgkmcnt(0)
    s_mov_b32 s12, s42
    s_and_b32 s13, s43, 0xffff
    s_mov_b32 s14, 663552
    s_mov_b32 s15, 0x00020000
f_weloop:
    v_mul_u32_u24 v6, 6554, v5
    v_lshrrev_b32 v6, 16, v6
    v_mul_u32_u24 v7, 10, v6
    v_sub_u32 v7, v5, v7
    v_lshl_add_u32 v176, v7, 4, s53
    v_and_b32 v7, 0x13, v6
    v_bfe_u32 v8, v6, 2, 1
    v_lshl_or_b32 v7, v8, 3, v7
    v_bfe_u32 v8, v6, 3, 1
    v_lshl_or_b32 v7, v8, 2, v7
    v_lshrrev_b32 v8, 4, v7
    v_lshl_add_u32 v7, v8, 1, v7
    v_mov_b32 v8, 1152
    v_mad_u32_u24 v176, v7, v8, v176
    s_mov_b32 m0, s51
    v_add_u32 v5, 64, v5
    buffer_load_dwordx4 v176, s[12:15], s50 offen lds
    s_add_u32 m0, s51, 20480
    s_add_u32 s51, s51, 1024
    buffer_load_dwordx4 v176, s[12:15], s52 offen lds
    s_add_u32 s18, s18, 1
    s_cmp_lt_u32 s18, 5
    s_cbranch_scc1 f_weloop
f_wex:
    s_cmp_eq_u32 s3, 7
    s_cbranch_scc1 f_qp
    s_mov_b32 s51, 1048576
f_qspin:
    ds_read_b32 v6, v255 offset:52
    s_sub_u32 s51, s51, 1
    s_cbranch_scc1 f_qspin_x
    s_waitcnt lgkmcnt(0)
    v_readfirstlane_b32 s50, v6
    s_cmp_ge_u32 s50, 1
    s_cbranch_scc1 f_qspin_x
    s_sleep 1
    s_branch f_qspin
f_qspin_x:
    s_branch f_qdone
f_qp:
    s_and_b32 s50, s44, 15
    s_mul_i32 s50, s50, 18
    v_and_b32 v2, 1, v1
    v_mad_u32_u24 v2, v2, 17, s50
    v_lshrrev_b32 v2, 5, v2
    v_bfe_u32 v3, v1, 1, 2
    v_mad_u32_u24 v2, v3, 9, v2
    s_and_b32 s51, s2, 1
    v_add_u32 v2, s51, v2
    v_lshrrev_b32 v2, 1, v2
    v_lshrrev_b32 v3, 3, v1
    v_lshl_add_u32 v2, v3, 4, v2
    s_and_b32 s50, s2, 1
    s_lshl_b32 s50, s50, 5
    s_lshl_b32 s51, s45, 2
    s_add_u32 s50, s50, s51
    s_lshl_b32 s50, s50, 11
    s_add_u32 s50, s50, 122880
    v_lshl_add_u32 v2, v2, 7, s50
    s_cmp_eq_u32 s46, 1
    s_cselect_b32 exec_lo, 0, 0x3c3c3c3c
    s_mov_b32 exec_hi, 0x3f3f3f3f
    s_mov_b32 s51, 65536
f_pollq:
    buffer_load_dwordx2 v[4:5], v2, s[32:35], 0 offen sc1
    s_sub_u32 s51, s51, 1
    s_cbranch_scc1 f_pollq_x
    s_waitcnt vmcnt(0)
    v_cmp_ne_u64 vcc, s[100:101], v[4:5]
    s_cbranch_vccz f_pollq_x
    s_mov_b64 exec, vcc
    s_sleep 4
    s_branch f_pollq
f_pollq_x:
    s_mov_b64 exec, -1
    v_mov_b32 v2, 1
    ds_write_b32 v255, v2 offset:52
f_qdone:
    s_lshl_b32 s50, s95, 10
    s_mov_b32 s51, 442368
    s_add_u32 m0, s50, 18432
    s_nop 0
    buffer_load_dwordx4 v120, s[8:11], 0 offen sc1 lds
    s_add_u32 m0, s50, 22528
    s_nop 0
    buffer_load_dwordx4 v122, s[8:11], 0 offen sc1 lds
    s_add_u32 m0, s50, 27648
    s_nop 0
    buffer_load_dwordx4 v120, s[8:11], s51 offen sc1 lds
    s_add_u32 m0, s50, 31744
    s_nop 0
    buffer_load_dwordx4 v122, s[8:11], s51 offen sc1 lds
    s_cmp_eq_u32 s95, 0
    s_cbranch_scc1 f_kv8
    s_mul_i32 s52, s95, 3072
    s_add_u32 m0, s52, 33792
    s_nop 0
    buffer_load_dwordx4 v126, s[8:11], 0 offen sc1 lds
    s_add_u32 m0, s52, 34816
    s_nop 0
    buffer_load_dwordx4 v127, s[8:11], 0 offen sc1 lds
    s_add_u32 m0, s52, 35840
    s_nop 0
    buffer_load_dwordx4 v128, s[8:11], 0 offen sc1 lds
    s_branch f_kv9
f_kv8:
    s_mov_b32 m0, 26624
    s_nop 0
    buffer_load_dwordx4 v124, s[8:11], 0 offen sc1 lds
    s_mov_b32 m0, 35840
    s_nop 0
    buffer_load_dwordx4 v124, s[8:11], s51 offen sc1 lds
    s_mov_b32 m0, 8192
    s_nop 0
    buffer_load_dwordx4 v125, s[8:11], 0 offen sc1 lds
    s_mov_b32 m0, 17408
    s_nop 0
    buffer_load_dwordx4 v125, s[8:11], s51 offen sc1 lds
f_kv9:
    s_add_u32 m0, s50, 0
    s_nop 0
    buffer_load_dwordx4 v121, s[8:11], 0 offen sc1 lds
    s_add_u32 m0, s50, 4096
    s_nop 0
    buffer_load_dwordx4 v123, s[8:11], 0 offen sc1 lds
    s_add_u32 m0, s50, 9216
    s_nop 0
    buffer_load_dwordx4 v121, s[8:11], s51 offen sc1 lds
    s_add_u32 m0, s50, 13312
    s_nop 0
    buffer_load_dwordx4 v123, s[8:11], s51 offen sc1 lds
    s_waitcnt vmcnt(0)
    v_mov_b32 v2, 1
    s_mov_b64 exec, 1
    ds_add_u32 v255, v2 offset:0
    s_mov_b64 exec, -1
    s_branch k2_attn
f_conv:
    s_mov_b32 s59, 0
    s_branch k2_setup
f_conv2:
    s_cmp_eq_u32 s59, 0
    s_cbranch_scc1 f_pqq
    s_waitcnt vmcnt(0)
    v_mov_b32 v10, s100
    v_mov_b32 v11, s101
    v_mov_b32 v12, 0
    s_mov_b64 exec, 1
    buffer_store_dwordx2 v[10:11], v12, s[32:35], s59 offen sc1
    s_mov_b64 exec, -1
    s_mov_b32 s59, 0
f_pqq:
    v_mov_b32 v2, 1
    s_mov_b64 exec, 1
    ds_add_u32 v255, v2 offset:92
    s_mov_b64 exec, -1
    v_mov_b64 v[16:17], 0
    v_mov_b64 v[18:19], 0
    v_mov_b64 v[20:21], 0
    v_mov_b64 v[22:23], 0
    v_mov_b64 v[24:25], 0
    v_mov_b64 v[26:27], 0
    v_mov_b64 v[28:29], 0
    v_mov_b64 v[30:31], 0
    v_mov_b64 v[32:33], 0
    v_mov_b64 v[34:35], 0
    v_mov_b64 v[36:37], 0
    v_mov_b64 v[38:39], 0
    v_mov_b64 v[40:41], 0
    v_mov_b64 v[42:43], 0
    v_mov_b64 v[44:45], 0
    v_mov_b64 v[46:47], 0
    s_lshl_b32 s50, s55, 2
    v_add_u32 v7, s50, v255
    s_add_u32 s12, s4, 8388608
    s_addc_u32 s13, s5, 0
    s_and_b32 s13, s13, 0xffff
    s_mov_b32 s14, 2359296
    s_mov_b32 s15, 0x00020000
    s_cmp_eq_u32 s3, 0
    s_cbranch_scc1 f_up
    s_mov_b32 s51, 1048576
f_useen:
    ds_read_b32 v6, v255 offset:32
    s_sub_u32 s51, s51, 1
    s_cbranch_scc1 f_useen_x
    s_waitcnt lgkmcnt(0)
    v_readfirstlane_b32 s50, v6
    s_cmp_ge_u32 s50, 1
    s_cbranch_scc1 f_useen_x
    s_sleep 1
    s_branch f_useen
f_useen_x:
    s_branch f_up2
f_up:
    s_lshr_b32 s50, s47, 6
    s_lshl_b32 s50, s50, 13
    v_lshl_add_u32 v2, v1, 7, s50
    s_mov_b32 s51, 65536
f_pollu:
    buffer_load_dwordx2 v[4:5], v2, s[32:35], 0 offen sc1
    s_sub_u32 s51, s51, 1
    s_cbranch_scc1 f_pollu_x
    s_waitcnt vmcnt(0)
    v_cmp_ne_u64 vcc, s[100:101], v[4:5]
    s_cbranch_vccz f_pollu_x
    s_mov_b64 exec, vcc
    s_sleep 4
    s_branch f_pollu
f_pollu_x:
    s_mov_b64 exec, -1
f_up3:
    v_mov_b32 v2, 1
    s_mov_b64 exec, 1
    ds_add_u32 v255, v2 offset:32
    s_mov_b64 exec, -1
f_up2:
    s_lshr_b32 s50, s47, 1
    s_lshl_b32 s50, s50, 13
    s_and_b32 s51, s47, 1
    s_lshl_b32 s51, s51, 6
    s_add_u32 s50, s50, s51
    s_lshl_b32 s51, s56, 12
    s_add_u32 s50, s50, s51
    v_lshrrev_b32 v3, 2, v1
    v_lshlrev_b32 v3, 7, v3
    v_and_b32 v4, 3, v1
    v_lshl_add_u32 v3, v4, 4, v3
    s_lshl_b32 s51, s56, 11
    s_add_u32 s51, s51, s6
    s_add_u32 m0, s51, 17120
    s_nop 0
    buffer_load_dwordx4 v3, s[12:15], s50 offen offset:0 sc1 lds
    s_add_u32 s50, s50, 1024
    buffer_load_dwordx4 v3, s[12:15], s50 offen offset:1024 sc1 lds
    s_add_u32 s50, s50, 1024
    s_cmp_eq_u32 s46, 0
    s_cbranch_scc1 f_udone
    buffer_load_dwordx4 v3, s[12:15], s50 offen offset:2048 sc1 lds
    s_add_u32 s50, s50, 1024
    buffer_load_dwordx4 v3, s[12:15], s50 offen offset:3072 sc1 lds
    s_add_u32 s50, s50, 1024
f_udone:
    s_add_u32 s51, s46, 1
    s_waitcnt vmcnt(0)
    v_mov_b32 v3, s51
    s_mov_b64 exec, 1
    ds_add_u32 v7, v3 offset:16
    s_mov_b64 exec, -1
    s_mov_b32 s51, 1048576
f_uspin:
    ds_read_b32 v6, v7 offset:16
    s_sub_u32 s51, s51, 1
    s_cbranch_scc1 f_uspin_x
    s_waitcnt lgkmcnt(0)
    v_readfirstlane_b32 s50, v6
    s_cmp_ge_u32 s50, 4
    s_cbranch_scc1 f_uspin_x
    s_sleep 1
    s_branch f_uspin
f_uspin_x:
    s_setprio 0
    ds_read_b64 v[48:49], v176 offset:0
    ds_read_b64 v[50:51], v176 offset:8
    ds_read_b128 v[80:83], v177 offset:128
    ds_read_b64 v[52:53], v176 offset:512
    ds_read_b64 v[54:55], v176 offset:520
    ds_read_b128 v[84:87], v177 offset:640
    ds_read_b64 v[56:57], v176 offset:1024
    ds_read_b64 v[58:59], v176 offset:1032
    ds_read_b128 v[88:91], v177 offset:1152
    ds_read_b64 v[60:61], v176 offset:1536
    ds_read_b64 v[62:63], v176 offset:1544
    ds_read_b128 v[92:95], v177 offset:1664
    ds_read_b64 v[64:65], v176 offset:2048
    ds_read_b64 v[66:67], v176 offset:2056
    ds_read_b128 v[96:99], v177 offset:2176
    ds_read_b64 v[68:69], v176 offset:2560
    ds_read_b64 v[70:71], v176 offset:2568
    ds_read_b128 v[100:103], v177 offset:2688
    ds_read_b64 v[72:73], v176 offset:3072
    ds_read_b64 v[74:75], v176 offset:3080
    ds_read_b128 v[104:107], v177 offset:3200
    ds_read_b64 v[76:77], v176 offset:3584
    ds_read_b64 v[78:79], v176 offset:3592
    ds_read_b128 v[108:111], v177 offset:3712
    s_lshl_b32 s52, s46, 1
    s_add_u32 s52, s52, 2
f_cvloop:
    s_waitcnt lgkmcnt(0)
    v_mfma_f32_16x16x32_bf16 v[16:19], v[48:51], v[80:83], v[16:19]
    ds_read_b64 v[112:113], v176 offset:64
    v_mfma_f32_16x16x32_bf16 v[20:23], v[52:55], v[80:83], v[20:23]
    ds_read_b64 v[114:115], v176 offset:72
    v_mfma_f32_16x16x32_bf16 v[20:23], v[48:51], v[84:87], v[20:23]
    ds_read_b128 v[144:147], v177 offset:64
    v_mfma_f32_16x16x32_bf16 v[24:27], v[52:55], v[84:87], v[24:27]
    ds_read_b64 v[116:117], v176 offset:576
    v_mfma_f32_16x16x32_bf16 v[24:27], v[56:59], v[80:83], v[24:27]
    ds_read_b64 v[118:119], v176 offset:584
    v_mfma_f32_16x16x32_bf16 v[24:27], v[48:51], v[88:91], v[24:27]
    ds_read_b128 v[148:151], v177 offset:576
    v_mfma_f32_16x16x32_bf16 v[28:31], v[56:59], v[84:87], v[28:31]
    ds_read_b64 v[120:121], v176 offset:1088
    v_mfma_f32_16x16x32_bf16 v[28:31], v[52:55], v[88:91], v[28:31]
    ds_read_b64 v[122:123], v176 offset:1096
    v_mfma_f32_16x16x32_bf16 v[32:35], v[56:59], v[88:91], v[32:35]
    ds_read_b128 v[152:155], v177 offset:1088
    v_mfma_f32_16x16x32_bf16 v[28:31], v[60:63], v[80:83], v[28:31]
    ds_read_b64 v[124:125], v176 offset:1600
    v_mfma_f32_16x16x32_bf16 v[28:31], v[48:51], v[92:95], v[28:31]
    ds_read_b64 v[126:127], v176 offset:1608
    v_mfma_f32_16x16x32_bf16 v[32:35], v[60:63], v[84:87], v[32:35]
    ds_read_b128 v[156:159], v177 offset:1600
    v_mfma_f32_16x16x32_bf16 v[32:35], v[52:55], v[92:95], v[32:35]
    ds_read_b64 v[128:129], v176 offset:2112
    v_mfma_f32_16x16x32_bf16 v[36:39], v[60:63], v[88:91], v[36:39]
    ds_read_b64 v[130:131], v176 offset:2120
    v_mfma_f32_16x16x32_bf16 v[36:39], v[56:59], v[92:95], v[36:39]
    ds_read_b128 v[160:163], v177 offset:2112
    v_mfma_f32_16x16x32_bf16 v[40:43], v[60:63], v[92:95], v[40:43]
    ds_read_b64 v[132:133], v176 offset:2624
    v_mfma_f32_16x16x32_bf16 v[32:35], v[64:67], v[80:83], v[32:35]
    ds_read_b64 v[134:135], v176 offset:2632
    v_mfma_f32_16x16x32_bf16 v[32:35], v[48:51], v[96:99], v[32:35]
    ds_read_b128 v[164:167], v177 offset:2624
    v_mfma_f32_16x16x32_bf16 v[36:39], v[64:67], v[84:87], v[36:39]
    ds_read_b64 v[136:137], v176 offset:3136
    v_mfma_f32_16x16x32_bf16 v[36:39], v[52:55], v[96:99], v[36:39]
    ds_read_b64 v[138:139], v176 offset:3144
    v_mfma_f32_16x16x32_bf16 v[40:43], v[64:67], v[88:91], v[40:43]
    ds_read_b128 v[168:171], v177 offset:3136
    v_mfma_f32_16x16x32_bf16 v[40:43], v[56:59], v[96:99], v[40:43]
    ds_read_b64 v[140:141], v176 offset:3648
    v_mfma_f32_16x16x32_bf16 v[44:47], v[64:67], v[92:95], v[44:47]
    ds_read_b64 v[142:143], v176 offset:3656
    v_mfma_f32_16x16x32_bf16 v[44:47], v[60:63], v[96:99], v[44:47]
    ds_read_b128 v[172:175], v177 offset:3648
    v_mfma_f32_16x16x32_bf16 v[36:39], v[68:71], v[80:83], v[36:39]
    v_mfma_f32_16x16x32_bf16 v[36:39], v[48:51], v[100:103], v[36:39]
    v_mfma_f32_16x16x32_bf16 v[40:43], v[68:71], v[84:87], v[40:43]
    v_mfma_f32_16x16x32_bf16 v[40:43], v[52:55], v[100:103], v[40:43]
    v_mfma_f32_16x16x32_bf16 v[44:47], v[68:71], v[88:91], v[44:47]
    v_mfma_f32_16x16x32_bf16 v[44:47], v[56:59], v[100:103], v[44:47]
    v_mfma_f32_16x16x32_bf16 v[40:43], v[72:75], v[80:83], v[40:43]
    v_mfma_f32_16x16x32_bf16 v[40:43], v[48:51], v[104:107], v[40:43]
    v_mfma_f32_16x16x32_bf16 v[44:47], v[72:75], v[84:87], v[44:47]
    v_mfma_f32_16x16x32_bf16 v[44:47], v[52:55], v[104:107], v[44:47]
    v_mfma_f32_16x16x32_bf16 v[44:47], v[76:79], v[80:83], v[44:47]
    v_mfma_f32_16x16x32_bf16 v[44:47], v[48:51], v[108:111], v[44:47]
    s_waitcnt lgkmcnt(0)
    v_mfma_f32_16x16x32_bf16 v[16:19], v[112:115], v[144:147], v[16:19]
    ds_read_b64 v[48:49], v176 offset:128
    v_mfma_f32_16x16x32_bf16 v[20:23], v[116:119], v[144:147], v[20:23]
    ds_read_b64 v[50:51], v176 offset:136
    v_mfma_f32_16x16x32_bf16 v[20:23], v[112:115], v[148:151], v[20:23]
    ds_read_b128 v[80:83], v177 offset:0
    v_mfma_f32_16x16x32_bf16 v[24:27], v[116:119], v[148:151], v[24:27]
    ds_read_b64 v[52:53], v176 offset:640
    v_mfma_f32_16x16x32_bf16 v[24:27], v[120:123], v[144:147], v[24:27]
    ds_read_b64 v[54:55], v176 offset:648
    v_mfma_f32_16x16x32_bf16 v[24:27], v[112:115], v[152:155], v[24:27]
    ds_read_b128 v[84:87], v177 offset:512
    v_mfma_f32_16x16x32_bf16 v[28:31], v[120:123], v[148:151], v[28:31]
    ds_read_b64 v[56:57], v176 offset:1152
    v_mfma_f32_16x16x32_bf16 v[28:31], v[116:119], v[152:155], v[28:31]
    ds_read_b64 v[58:59], v176 offset:1160
    v_mfma_f32_16x16x32_bf16 v[32:35], v[120:123], v[152:155], v[32:35]
    ds_read_b128 v[88:91], v177 offset:1024
    v_mfma_f32_16x16x32_bf16 v[28:31], v[124:127], v[144:147], v[28:31]
    ds_read_b64 v[60:61], v176 offset:1664
    v_mfma_f32_16x16x32_bf16 v[28:31], v[112:115], v[156:159], v[28:31]
    ds_read_b64 v[62:63], v176 offset:1672
    v_mfma_f32_16x16x32_bf16 v[32:35], v[124:127], v[148:151], v[32:35]
    ds_read_b128 v[92:95], v177 offset:1536
    v_mfma_f32_16x16x32_bf16 v[32:35], v[116:119], v[156:159], v[32:35]
    ds_read_b64 v[64:65], v176 offset:2176
    v_mfma_f32_16x16x32_bf16 v[36:39], v[124:127], v[152:155], v[36:39]
    ds_read_b64 v[66:67], v176 offset:2184
    v_mfma_f32_16x16x32_bf16 v[36:39], v[120:123], v[156:159], v[36:39]
    ds_read_b128 v[96:99], v177 offset:2048
    v_mfma_f32_16x16x32_bf16 v[40:43], v[124:127], v[156:159], v[40:43]
    ds_read_b64 v[68:69], v176 offset:2688
    v_mfma_f32_16x16x32_bf16 v[32:35], v[128:131], v[144:147], v[32:35]
    ds_read_b64 v[70:71], v176 offset:2696
    v_mfma_f32_16x16x32_bf16 v[32:35], v[112:115], v[160:163], v[32:35]
    ds_read_b128 v[100:103], v177 offset:2560
    v_mfma_f32_16x16x32_bf16 v[36:39], v[128:131], v[148:151], v[36:39]
    ds_read_b64 v[72:73], v176 offset:3200
    v_mfma_f32_16x16x32_bf16 v[36:39], v[116:119], v[160:163], v[36:39]
    ds_read_b64 v[74:75], v176 offset:3208
    v_mfma_f32_16x16x32_bf16 v[40:43], v[128:131], v[152:155], v[40:43]
    ds_read_b128 v[104:107], v177 offset:3072
    v_mfma_f32_16x16x32_bf16 v[40:43], v[120:123], v[160:163], v[40:43]
    ds_read_b64 v[76:77], v176 offset:3712
    v_mfma_f32_16x16x32_bf16 v[44:47], v[128:131], v[156:159], v[44:47]
    ds_read_b64 v[78:79], v176 offset:3720
    v_mfma_f32_16x16x32_bf16 v[44:47], v[124:127], v[160:163], v[44:47]
    ds_read_b128 v[108:111], v177 offset:3584
    v_mfma_f32_16x16x32_bf16 v[36:39], v[132:135], v[144:147], v[36:39]
    v_mfma_f32_16x16x32_bf16 v[36:39], v[112:115], v[164:167], v[36:39]
    v_mfma_f32_16x16x32_bf16 v[40:43], v[132:135], v[148:151], v[40:43]
    v_mfma_f32_16x16x32_bf16 v[40:43], v[116:119], v[164:167], v[40:43]
    v_mfma_f32_16x16x32_bf16 v[44:47], v[132:135], v[152:155], v[44:47]
    v_mfma_f32_16x16x32_bf16 v[44:47], v[120:123], v[164:167], v[44:47]
    v_mfma_f32_16x16x32_bf16 v[40:43], v[136:139], v[144:147], v[40:43]
    v_mfma_f32_16x16x32_bf16 v[40:43], v[112:115], v[168:171], v[40:43]
    v_mfma_f32_16x16x32_bf16 v[44:47], v[136:139], v[148:151], v[44:47]
    v_mfma_f32_16x16x32_bf16 v[44:47], v[116:119], v[168:171], v[44:47]
    v_mfma_f32_16x16x32_bf16 v[44:47], v[140:143], v[144:147], v[44:47]
    v_mfma_f32_16x16x32_bf16 v[44:47], v[112:115], v[172:175], v[44:47]
    v_add_u32 v176, 128, v176
    v_subrev_u32 v177, 128, v177
    s_sub_u32 s52, s52, 1
    s_cmp_lg_u32 s52, 0
    s_cbranch_scc1 f_cvloop
    s_lshl_b32 s50, s55, 13
    s_add_u32 s50, s50, 104832
    v_lshl_add_u32 v2, v1, 4, s50
    s_waitcnt lgkmcnt(0)
    s_cmp_eq_u32 s56, 0
    s_cbranch_scc1 f_cfin
    v_mov_b32 v4, 1
    ds_write_b128 v2, v[16:19] offset:0
    ds_write_b128 v2, v[20:23] offset:1024
    ds_write_b128 v2, v[24:27] offset:2048
    ds_write_b128 v2, v[28:31] offset:3072
    ds_write_b128 v2, v[32:35] offset:4096
    ds_write_b128 v2, v[36:39] offset:5120
    ds_write_b128 v2, v[40:43] offset:6144
    ds_write_b128 v2, v[44:47] offset:7168
    s_waitcnt lgkmcnt(0)
    ds_write_b32 v7, v4 offset:4
    v_mov_b32 v2, 1
    s_mov_b64 exec, 1
    ds_add_u32 v255, v2 offset:60
    s_mov_b64 exec, -1
    s_branch f_wo
f_cfin:
    v_and_b32 v4, 15, v1
    v_lshrrev_b32 v5, 4, v1
    v_xor_b32 v3, 1, v5
    v_lshl_add_u32 v3, v3, 3, s6
    v_lshl_add_u32 v3, v4, 5, v3
    ds_read_b64 v[48:49], v3 offset:17120
    ds_read_b64 v[50:51], v3 offset:17632
    ds_read_b64 v[52:53], v3 offset:18144
    ds_read_b64 v[54:55], v3 offset:18656
    ds_read_b64 v[56:57], v3 offset:19168
    ds_read_b64 v[58:59], v3 offset:19680
    ds_read_b64 v[60:61], v3 offset:20192
    ds_read_b64 v[62:63], v3 offset:20704
    s_lshl_b32 s50, s47, 12
    v_lshl_add_u32 v4, v4, 5, s50
    v_and_b32 v3, 1, v5
    v_lshl_add_u32 v4, v3, 9, v4
    v_lshrrev_b32 v5, 1, v5
    v_lshl_add_u32 v5, v5, 4, v4
    s_waitcnt vmcnt(0) lgkmcnt(0)
    v_lshlrev_b32 v178, 16, v178
    v_and_b32 v8, 0xffff0000, v49
    v_lshlrev_b32 v9, 16, v49
    v_and_b32 v10, 0xffff0000, v48
    v_lshlrev_b32 v11, 16, v48
    v_fmac_f32 v16, v8, v178
    v_fmac_f32 v17, v9, v178
    v_fmac_f32 v18, v10, v178
    v_fmac_f32 v19, v11, v178
    v_and_b32 v8, 0xffff0000, v51
    v_lshlrev_b32 v9, 16, v51
    v_and_b32 v10, 0xffff0000, v50
    v_lshlrev_b32 v11, 16, v50
    v_fmac_f32 v20, v8, v178
    v_fmac_f32 v21, v9, v178
    v_fmac_f32 v22, v10, v178
    v_fmac_f32 v23, v11, v178
    v_and_b32 v8, 0xffff0000, v53
    v_lshlrev_b32 v9, 16, v53
    v_and_b32 v10, 0xffff0000, v52
    v_lshlrev_b32 v11, 16, v52
    v_fmac_f32 v24, v8, v178
    v_fmac_f32 v25, v9, v178
    v_fmac_f32 v26, v10, v178
    v_fmac_f32 v27, v11, v178
    v_and_b32 v8, 0xffff0000, v55
    v_lshlrev_b32 v9, 16, v55
    v_and_b32 v10, 0xffff0000, v54
    v_lshlrev_b32 v11, 16, v54
    v_fmac_f32 v28, v8, v178
    v_fmac_f32 v29, v9, v178
    v_fmac_f32 v30, v10, v178
    v_fmac_f32 v31, v11, v178
    v_and_b32 v8, 0xffff0000, v57
    v_lshlrev_b32 v9, 16, v57
    v_and_b32 v10, 0xffff0000, v56
    v_lshlrev_b32 v11, 16, v56
    v_fmac_f32 v32, v8, v178
    v_fmac_f32 v33, v9, v178
    v_fmac_f32 v34, v10, v178
    v_fmac_f32 v35, v11, v178
    v_and_b32 v8, 0xffff0000, v59
    v_lshlrev_b32 v9, 16, v59
    v_and_b32 v10, 0xffff0000, v58
    v_lshlrev_b32 v11, 16, v58
    v_fmac_f32 v36, v8, v178
    v_fmac_f32 v37, v9, v178
    v_fmac_f32 v38, v10, v178
    v_fmac_f32 v39, v11, v178
    v_and_b32 v8, 0xffff0000, v61
    v_lshlrev_b32 v9, 16, v61
    v_and_b32 v10, 0xffff0000, v60
    v_lshlrev_b32 v11, 16, v60
    v_fmac_f32 v40, v8, v178
    v_fmac_f32 v41, v9, v178
    v_fmac_f32 v42, v10, v178
    v_fmac_f32 v43, v11, v178
    v_and_b32 v8, 0xffff0000, v63
    v_lshlrev_b32 v9, 16, v63
    v_and_b32 v10, 0xffff0000, v62
    v_lshlrev_b32 v11, 16, v62
    v_fmac_f32 v44, v8, v178
    v_fmac_f32 v45, v9, v178
    v_fmac_f32 v46, v10, v178
    v_fmac_f32 v47, v11, v178
    s_cmp_eq_u32 s46, 1
    s_cbranch_scc1 f_zout
    s_mov_b32 s51, 1048576
f_pspin:
    ds_read_b32 v6, v7 offset:4
    s_sub_u32 s51, s51, 1
    s_cbranch_scc1 f_pspin_x
    s_waitcnt lgkmcnt(0)
    v_readfirstlane_b32 s50, v6
    s_cmp_ge_u32 s50, 1
    s_cbranch_scc1 f_pspin_x
    s_sleep 1
    s_branch f_pspin
f_pspin_x:
    ds_read_b128 v[80:83], v2 offset:0
    ds_read_b128 v[84:87], v2 offset:1024
    ds_read_b128 v[88:91], v2 offset:2048
    ds_read_b128 v[92:95], v2 offset:3072
    ds_read_b128 v[96:99], v2 offset:4096
    ds_read_b128 v[100:103], v2 offset:5120
    ds_read_b128 v[104:107], v2 offset:6144
    ds_read_b128 v[108:111], v2 offset:7168
    s_waitcnt lgkmcnt(7)
    v_add_f32 v16, v16, v80
    v_add_f32 v17, v17, v81
    v_add_f32 v18, v18, v82
    v_add_f32 v19, v19, v83
    s_waitcnt lgkmcnt(6)
    v_add_f32 v20, v20, v84
    v_add_f32 v21, v21, v85
    v_add_f32 v22, v22, v86
    v_add_f32 v23, v23, v87
    s_waitcnt lgkmcnt(5)
    v_add_f32 v24, v24, v88
    v_add_f32 v25, v25, v89
    v_add_f32 v26, v26, v90
    v_add_f32 v27, v27, v91
    s_waitcnt lgkmcnt(4)
    v_add_f32 v28, v28, v92
    v_add_f32 v29, v29, v93
    v_add_f32 v30, v30, v94
    v_add_f32 v31, v31, v95
    s_waitcnt lgkmcnt(3)
    v_add_f32 v32, v32, v96
    v_add_f32 v33, v33, v97
    v_add_f32 v34, v34, v98
    v_add_f32 v35, v35, v99
    s_waitcnt lgkmcnt(2)
    v_add_f32 v36, v36, v100
    v_add_f32 v37, v37, v101
    v_add_f32 v38, v38, v102
    v_add_f32 v39, v39, v103
    s_waitcnt lgkmcnt(1)
    v_add_f32 v40, v40, v104
    v_add_f32 v41, v41, v105
    v_add_f32 v42, v42, v106
    v_add_f32 v43, v43, v107
    s_waitcnt lgkmcnt(0)
    v_add_f32 v44, v44, v108
    v_add_f32 v45, v45, v109
    v_add_f32 v46, v46, v110
    v_add_f32 v47, v47, v111
f_zout:
    v_mov_b32 v2, 1
    s_mov_b64 exec, 1
    ds_add_u32 v255, v2 offset:60
    s_mov_b64 exec, -1
    v_cvt_pk_bf16_f32 v48, v16, v17
    v_cvt_pk_bf16_f32 v49, v18, v19
    v_cvt_pk_bf16_f32 v50, v20, v21
    v_cvt_pk_bf16_f32 v51, v22, v23
    s_nop 1
    v_permlane16_swap_b32 v48, v50
    v_permlane16_swap_b32 v49, v51
    buffer_store_dwordx4 v[48:51], v5, s[20:23], 0 offen offset:0 sc1
    v_cvt_pk_bf16_f32 v52, v24, v25
    v_cvt_pk_bf16_f32 v53, v26, v27
    v_cvt_pk_bf16_f32 v54, v28, v29
    v_cvt_pk_bf16_f32 v55, v30, v31
    s_nop 1
    v_permlane16_swap_b32 v52, v54
    v_permlane16_swap_b32 v53, v55
    buffer_store_dwordx4 v[52:55], v5, s[20:23], 0 offen offset:1024 sc1
    v_cvt_pk_bf16_f32 v56, v32, v33
    v_cvt_pk_bf16_f32 v57, v34, v35
    v_cvt_pk_bf16_f32 v58, v36, v37
    v_cvt_pk_bf16_f32 v59, v38, v39
    s_nop 1
    v_permlane16_swap_b32 v56, v58
    v_permlane16_swap_b32 v57, v59
    buffer_store_dwordx4 v[56:59], v5, s[20:23], 0 offen offset:2048 sc1
    v_cvt_pk_bf16_f32 v60, v40, v41
    v_cvt_pk_bf16_f32 v61, v42, v43
    v_cvt_pk_bf16_f32 v62, v44, v45
    v_cvt_pk_bf16_f32 v63, v46, v47
    s_nop 1
    v_permlane16_swap_b32 v60, v62
    v_permlane16_swap_b32 v61, v63
    buffer_store_dwordx4 v[60:63], v5, s[20:23], 0 offen offset:3072 sc1
    s_lshl_b32 s59, s47, 7
    s_add_u32 s59, s59, 262144
f_wo:
    s_setprio 0
k2_attn:
    s_mov_b32 s51, 1048576
f_kvspin:
    ds_read_b32 v6, v255 offset:0
    s_sub_u32 s51, s51, 1
    s_cbranch_scc1 f_kvspin_x
    s_waitcnt lgkmcnt(0)
    v_readfirstlane_b32 s50, v6
    s_cmp_ge_u32 s50, 4
    s_cbranch_scc1 f_kvspin_x
    s_sleep 1
    s_branch f_kvspin
f_kvspin_x:
k2_attn2:
    v_mov_b32 v2, 1
    s_mov_b64 exec, 1
    ds_add_rtn_u32 v3, v255, v2 offset:12
    s_mov_b64 exec, -1
    s_waitcnt lgkmcnt(0)
    v_readfirstlane_b32 s50, v3
    s_cmp_ge_u32 s50, 8
    s_cbranch_scc1 k2_end
    s_sub_u32 s50, 7, s50
    s_add_u32 s51, s50, 1
    s_cmp_eq_u32 s46, 1
    s_cselect_b32 s57, s51, 9
    s_sub_u32 s51, s50, s48
    s_mov_b32 s48, s50
    s_mul_i32 s50, s51, 1152
    v_add_u32 v207, s50, v207
    v_add_u32 v208, s50, v208
    s_lshl_b32 s50, s50, 1
    v_add_u32 v204, s50, v204
    v_add_u32 v205, s50, v205
    v_add_u32 v206, s50, v206
    s_lshl_b32 s50, s51, 9
    v_add_u32 v210, s50, v210
    v_add_u32 v211, s50, v211
    v_mov_b64 v[236:237], 0
    v_mov_b64 v[238:239], 0
    v_mov_b64 v[240:241], 0
    v_mov_b64 v[242:243], 0
    ds_read_b64_tr_b16 v[244:245], v207 offset:36864
    ds_read_b64_tr_b16 v[246:247], v207 offset:36928
    ds_read_b64_tr_b16 v[248:249], v208 offset:36864
    ds_read_b64_tr_b16 v[224:225], v204 offset:18432
    ds_read_b64_tr_b16 v[226:227], v204 offset:18496
    ds_read_b64_tr_b16 v[228:229], v205 offset:18432
    ds_read_b64_tr_b16 v[230:231], v204 offset:16128
    ds_read_b64_tr_b16 v[232:233], v204 offset:16192
    ds_read_b64_tr_b16 v[234:235], v205 offset:16128
    v_mov_b32 v212, 0xff800000
    v_mov_b32 v213, v212
    v_mov_b64 v[250:251], 0
    s_waitcnt lgkmcnt(6)
    v_mov_b32 v249, 0
    s_mov_b32 exec_lo, 0
    v_mov_b32 v248, 0
    s_mov_b32 exec_lo, -1
    s_waitcnt lgkmcnt(0)
    v_mfma_f32_32x32x16_bf16 v[144:159], v[224:227], v[244:247], 0
    v_mfma_f32_32x32x16_bf16 v[144:159], v[228:231], v[248:251], v[144:159]
    ds_read_b64_tr_b16 v[236:237], v204 offset:13824
    ds_read_b64_tr_b16 v[238:239], v204 offset:13888
    ds_read_b64_tr_b16 v[240:241], v205 offset:13824
    s_waitcnt lgkmcnt(3)
    v_mfma_f32_32x32x16_bf16 v[128:143], v[230:233], v[244:247], 0
    v_mfma_f32_32x32x16_bf16 v[128:143], v[234:237], v[248:251], v[128:143]
    ds_read_b64_tr_b16 v[224:225], v204 offset:11520
    ds_read_b64_tr_b16 v[226:227], v204 offset:11584
    ds_read_b64_tr_b16 v[228:229], v205 offset:11520
    s_waitcnt lgkmcnt(3)
    v_mfma_f32_32x32x16_bf16 v[112:127], v[236:239], v[244:247], 0
    s_cmp_eq_u32 s57, 1
    v_mfma_f32_32x32x16_bf16 v[112:127], v[240:243], v[248:251], v[112:127]
    ds_read_b64_tr_b16 v[230:231], v204 offset:9216
    ds_read_b64_tr_b16 v[232:233], v204 offset:9280
    ds_read_b64_tr_b16 v[234:235], v205 offset:9216
    s_cbranch_scc1 k2_light
    s_waitcnt lgkmcnt(3)
    v_mfma_f32_32x32x16_bf16 v[96:111], v[224:227], v[244:247], 0
    v_max3_f32 v212, v128, v129, v212
    v_max3_f32 v213, v130, v131, v213
    v_max3_f32 v212, v132, v133, v212
    v_max3_f32 v213, v134, v135, v213
    s_cmp_eq_u32 s57, 2
    v_mfma_f32_32x32x16_bf16 v[96:111], v[228:231], v[248:251], v[96:111]
    ds_read_b64_tr_b16 v[236:237], v204 offset:6912
    ds_read_b64_tr_b16 v[238:239], v204 offset:6976
    ds_read_b64_tr_b16 v[240:241], v205 offset:6912
    v_max3_f32 v212, v136, v137, v212
    v_max3_f32 v213, v138, v139, v213
    v_max3_f32 v212, v140, v141, v212
    v_max3_f32 v213, v142, v143, v213
    s_cbranch_scc1 k2_light
    s_waitcnt lgkmcnt(3)
    v_mfma_f32_32x32x16_bf16 v[80:95], v[230:233], v[244:247], 0
    v_max3_f32 v212, v112, v113, v212
    v_max3_f32 v213, v114, v115, v213
    v_max3_f32 v212, v116, v117, v212
    v_max3_f32 v213, v118, v119, v213
    s_cmp_eq_u32 s57, 3
    v_mfma_f32_32x32x16_bf16 v[80:95], v[234:237], v[248:251], v[80:95]
    ds_read_b64_tr_b16 v[224:225], v204 offset:4608
    ds_read_b64_tr_b16 v[226:227], v204 offset:4672
    ds_read_b64_tr_b16 v[228:229], v205 offset:4608
    v_max3_f32 v212, v120, v121, v212
    v_max3_f32 v213, v122, v123, v213
    v_max3_f32 v212, v124, v125, v212
    v_max3_f32 v213, v126, v127, v213
    s_cbranch_scc1 k2_light
    s_waitcnt lgkmcnt(3)
    v_mfma_f32_32x32x16_bf16 v[64:79], v[236:239], v[244:247], 0
    v_max3_f32 v212, v96, v97, v212
    v_max3_f32 v213, v98, v99, v213
    v_max3_f32 v212, v100, v101, v212
    v_max3_f32 v213, v102, v103, v213
    s_cmp_eq_u32 s57, 4
    v_mfma_f32_32x32x16_bf16 v[64:79], v[240:243], v[248:251], v[64:79]
    ds_read_b64_tr_b16 v[230:231], v204 offset:2304
    ds_read_b64_tr_b16 v[232:233], v204 offset:2368
    ds_read_b64_tr_b16 v[234:235], v205 offset:2304
    v_max3_f32 v212, v104, v105, v212
    v_max3_f32 v213, v106, v107, v213
    v_max3_f32 v212, v108, v109, v212
    v_max3_f32 v213, v110, v111, v213
    s_cbranch_scc1 k2_light
    s_waitcnt lgkmcnt(3)
    v_mfma_f32_32x32x16_bf16 v[48:63], v[224:227], v[244:247], 0
    v_max3_f32 v212, v80, v81, v212
    v_max3_f32 v213, v82, v83, v213
    v_max3_f32 v212, v84, v85, v212
    v_max3_f32 v213, v86, v87, v213
    s_cmp_eq_u32 s57, 5
    v_mfma_f32_32x32x16_bf16 v[48:63], v[228:231], v[248:251], v[48:63]
    ds_read_b64_tr_b16 v[236:237], v204 offset:0
    ds_read_b64_tr_b16 v[238:239], v204 offset:64
    ds_read_b64_tr_b16 v[240:241], v205 offset:0
    v_max3_f32 v212, v88, v89, v212
    v_max3_f32 v213, v90, v91, v213
    v_max3_f32 v212, v92, v93, v212
    v_max3_f32 v213, v94, v95, v213
    s_cbranch_scc1 k2_light
    s_waitcnt lgkmcnt(3)
    v_mfma_f32_32x32x16_bf16 v[32:47], v[230:233], v[244:247], 0
    v_max3_f32 v212, v64, v65, v212
    v_max3_f32 v213, v66, v67, v213
    v_max3_f32 v212, v68, v69, v212
    v_max3_f32 v213, v70, v71, v213
    s_cmp_eq_u32 s57, 6
    v_mfma_f32_32x32x16_bf16 v[32:47], v[234:237], v[248:251], v[32:47]
    v_max3_f32 v212, v72, v73, v212
    v_max3_f32 v213, v74, v75, v213
    v_max3_f32 v212, v76, v77, v212
    v_max3_f32 v213, v78, v79, v213
    s_cbranch_scc1 k2_light
    s_waitcnt lgkmcnt(0)
    v_mfma_f32_32x32x16_bf16 v[16:31], v[236:239], v[244:247], 0
    v_max3_f32 v212, v48, v49, v212
    v_max3_f32 v213, v50, v51, v213
    v_max3_f32 v212, v52, v53, v212
    v_max3_f32 v213, v54, v55, v213
    s_cmp_eq_u32 s57, 7
    v_mfma_f32_32x32x16_bf16 v[16:31], v[240:243], v[248:251], v[16:31]
    v_max3_f32 v212, v56, v57, v212
    v_max3_f32 v213, v58, v59, v213
    v_max3_f32 v212, v60, v61, v212
    v_max3_f32 v213, v62, v63, v213
    s_cbranch_scc1 k2_light
    v_max3_f32 v212, v32, v33, v212
    v_max3_f32 v213, v34, v35, v213
    v_max3_f32 v212, v36, v37, v212
    v_max3_f32 v213, v38, v39, v213
    v_max3_f32 v212, v40, v41, v212
    v_max3_f32 v213, v42, v43, v213
    v_max3_f32 v212, v44, v45, v212
    v_max3_f32 v213, v46, v47, v213
    s_cmp_eq_u32 s57, 9
    s_cbranch_scc1 k2_merge
k2_light:
    s_nop 7
    v_mov_b32 v16, 0xff800000
    v_mov_b32 v17, v16
    v_mov_b64 v[18:19], v[16:17]
    v_mov_b64 v[20:21], v[16:17]
    v_mov_b64 v[22:23], v[16:17]
    v_mov_b64 v[24:25], v[16:17]
    v_mov_b64 v[26:27], v[16:17]
    v_mov_b64 v[28:29], v[16:17]
    v_mov_b64 v[30:31], v[16:17]
k2_merge:
    s_cmp_eq_u32 s59, 0
    s_cbranch_scc1 f_pa
    s_waitcnt vmcnt(0)
    v_mov_b32 v10, s100
    v_mov_b32 v11, s101
    v_mov_b32 v12, 0
    s_mov_b64 exec, 1
    buffer_store_dwordx2 v[10:11], v12, s[32:35], s59 offen sc1
    s_mov_b64 exec, -1
    s_mov_b32 s59, 0
f_pa:
    s_mov_b64 exec, s[92:93]
    ds_read_b128 v[180:183], v206 offset:18720
    ds_read_b128 v[184:187], v206 offset:19872
    ds_read_b128 v[188:191], v206 offset:288
    ds_read_b128 v[192:195], v206 offset:1440
    s_mov_b64 exec, -1
    v_cndmask_b32 v144, v16, v144, s[60:61]
    v_cndmask_b32 v145, v17, v145, s[62:63]
    v_cndmask_b32 v146, v18, v146, s[64:65]
    v_cndmask_b32 v147, v19, v147, s[66:67]
    v_cndmask_b32 v148, v20, v148, s[68:69]
    v_cndmask_b32 v149, v21, v149, s[70:71]
    v_cndmask_b32 v150, v22, v150, s[72:73]
    v_cndmask_b32 v151, v23, v151, s[74:75]
    v_cndmask_b32 v152, v24, v152, s[76:77]
    v_cndmask_b32 v153, v25, v153, s[78:79]
    v_cndmask_b32 v154, v26, v154, s[80:81]
    v_cndmask_b32 v155, v27, v155, s[82:83]
    v_cndmask_b32 v156, v28, v156, s[84:85]
    v_cndmask_b32 v157, v29, v157, s[86:87]
    v_cndmask_b32 v158, v30, v158, s[88:89]
    v_cndmask_b32 v159, v31, v159, s[90:91]
    v_max3_f32 v212, v144, v145, v212
    v_max3_f32 v213, v146, v147, v213
    v_max3_f32 v212, v148, v149, v212
    v_max3_f32 v213, v150, v151, v213
    v_max3_f32 v212, v152, v153, v212
    v_max3_f32 v213, v154, v155, v213
    v_max3_f32 v212, v156, v157, v212
    v_max3_f32 v213, v158, v159, v213
    v_max_f32 v212, v212, v213
    v_mov_b32 v213, v212
    s_nop 1
    v_permlane32_swap_b32 v212, v213
    s_nop 1
    v_max_f32 v212, v212, v213
    v_cvt_pk_bf16_f32 v214, -v212, -v212
    v_and_b32 v215, 0xffff0000, v214
    v_sub_f32 v215, -v212, v215
    v_cvt_pk_bf16_f32 v248, -v212, v215
    s_waitcnt lgkmcnt(0)
    v_mov_b32 v236, v209
    v_mov_b32 v237, 0
    v_mov_b64 v[238:239], 0
    s_nop 1
    v_mfma_f32_32x32x16_bf16 v[144:159], v[236:239], v[248:251], v[144:159]
    v_mfma_f32_32x32x16_bf16 v[128:143], v[236:239], v[248:251], v[128:143]
    s_nop 7
    s_nop 2
    v_exp_f32 v144, v144
    v_exp_f32 v145, v145
    v_exp_f32 v146, v146
    v_exp_f32 v147, v147
    v_exp_f32 v148, v148
    v_exp_f32 v149, v149
    v_exp_f32 v150, v150
    v_exp_f32 v151, v151
    v_mfma_f32_32x32x16_bf16 v[112:127], v[236:239], v[248:251], v[112:127]
    v_exp_f32 v152, v152
    v_exp_f32 v153, v153
    v_exp_f32 v154, v154
    v_exp_f32 v155, v155
    v_exp_f32 v156, v156
    v_exp_f32 v157, v157
    v_exp_f32 v158, v158
    v_exp_f32 v159, v159
    v_cvt_pk_bf16_f32 v144, v144, v145
    v_cvt_pk_bf16_f32 v145, v146, v147
    v_cvt_pk_bf16_f32 v146, v148, v149
    v_cvt_pk_bf16_f32 v147, v150, v151
    v_cvt_pk_bf16_f32 v148, v152, v153
    v_cvt_pk_bf16_f32 v149, v154, v155
    v_cvt_pk_bf16_f32 v150, v156, v157
    v_cvt_pk_bf16_f32 v151, v158, v159
    v_bfi_b32 v16, v196, 0, v144
    v_and_b32 v144, v196, v144
    v_bfi_b32 v17, v197, 0, v145
    v_and_b32 v145, v197, v145
    v_bfi_b32 v18, v198, 0, v146
    v_and_b32 v146, v198, v146
    v_bfi_b32 v19, v199, 0, v147
    v_and_b32 v147, v199, v147
    v_bfi_b32 v20, v200, 0, v148
    v_and_b32 v148, v200, v148
    v_bfi_b32 v21, v201, 0, v149
    v_and_b32 v149, v201, v149
    v_bfi_b32 v22, v202, 0, v150
    v_and_b32 v150, v202, v150
    v_bfi_b32 v23, v203, 0, v151
    v_and_b32 v151, v203, v151
    s_cmp_eq_u32 s57, 1
    s_cbranch_scc1 k2_pvx1
    v_mfma_f32_32x32x16_bf16 v[160:175], v[180:183], v[144:147], 0
    v_exp_f32 v128, v128
    v_exp_f32 v129, v129
    v_exp_f32 v130, v130
    v_mfma_f32_32x32x16_bf16 v[160:175], v[184:187], v[148:151], v[160:175]
    s_mov_b64 exec, s[92:93]
    ds_read_b128 v[180:183], v206 offset:16416
    ds_read_b128 v[184:187], v206 offset:17568
    s_mov_b64 exec, -1
    v_exp_f32 v131, v131
    v_exp_f32 v132, v132
    v_exp_f32 v133, v133
    v_mfma_f32_32x32x16_bf16 v[160:175], v[188:191], v[16:19], v[160:175]
    v_exp_f32 v134, v134
    v_exp_f32 v135, v135
    v_exp_f32 v136, v136
    v_mfma_f32_32x32x16_bf16 v[160:175], v[192:195], v[20:23], v[160:175]
    v_exp_f32 v137, v137
    v_exp_f32 v138, v138
    v_exp_f32 v139, v139
    v_mfma_f32_32x32x16_bf16 v[96:111], v[236:239], v[248:251], v[96:111]
    v_exp_f32 v140, v140
    v_exp_f32 v141, v141
    v_exp_f32 v142, v142
    v_exp_f32 v143, v143
    v_cvt_pk_bf16_f32 v128, v128, v129
    v_cvt_pk_bf16_f32 v129, v130, v131
    v_cvt_pk_bf16_f32 v130, v132, v133
    v_cvt_pk_bf16_f32 v131, v134, v135
    v_cvt_pk_bf16_f32 v132, v136, v137
    v_cvt_pk_bf16_f32 v133, v138, v139
    v_cvt_pk_bf16_f32 v134, v140, v141
    v_cvt_pk_bf16_f32 v135, v142, v143
    s_cmp_eq_u32 s57, 2
    s_cbranch_scc1 k2_pvx2
    s_waitcnt lgkmcnt(0)
    v_mfma_f32_32x32x16_bf16 v[160:175], v[180:183], v[128:131], v[160:175]
    s_mov_b64 exec, s[92:93]
    ds_read_b128 v[188:191], v206 offset:14112
    ds_read_b128 v[192:195], v206 offset:15264
    s_mov_b64 exec, -1
    v_exp_f32 v112, v112
    v_exp_f32 v113, v113
    v_exp_f32 v114, v114
    v_exp_f32 v115, v115
    v_mfma_f32_32x32x16_bf16 v[160:175], v[184:187], v[132:135], v[160:175]
    v_exp_f32 v116, v116
    v_exp_f32 v117, v117
    v_exp_f32 v118, v118
    v_exp_f32 v119, v119
    v_mfma_f32_32x32x16_bf16 v[80:95], v[236:239], v[248:251], v[80:95]
    v_exp_f32 v120, v120
    v_exp_f32 v121, v121
    v_exp_f32 v122, v122
    v_exp_f32 v123, v123
    v_exp_f32 v124, v124
    v_exp_f32 v125, v125
    v_exp_f32 v126, v126
    v_exp_f32 v127, v127
    v_cvt_pk_bf16_f32 v112, v112, v113
    v_cvt_pk_bf16_f32 v113, v114, v115
    v_cvt_pk_bf16_f32 v114, v116, v117
    v_cvt_pk_bf16_f32 v115, v118, v119
    v_cvt_pk_bf16_f32 v116, v120, v121
    v_cvt_pk_bf16_f32 v117, v122, v123
    v_cvt_pk_bf16_f32 v118, v124, v125
    v_cvt_pk_bf16_f32 v119, v126, v127
    s_cmp_eq_u32 s57, 3
    s_cbranch_scc1 k2_pvx3
    s_waitcnt lgkmcnt(0)
    v_mfma_f32_32x32x16_bf16 v[160:175], v[188:191], v[112:115], v[160:175]
    s_mov_b64 exec, s[92:93]
    ds_read_b128 v[180:183], v206 offset:11808
    ds_read_b128 v[184:187], v206 offset:12960
    s_mov_b64 exec, -1
    v_exp_f32 v96, v96
    v_exp_f32 v97, v97
    v_exp_f32 v98, v98
    v_exp_f32 v99, v99
    v_mfma_f32_32x32x16_bf16 v[160:175], v[192:195], v[116:119], v[160:175]
    v_exp_f32 v100, v100
    v_exp_f32 v101, v101
    v_exp_f32 v102, v102
    v_exp_f32 v103, v103
    v_mfma_f32_32x32x16_bf16 v[64:79], v[236:239], v[248:251], v[64:79]
    v_exp_f32 v104, v104
    v_exp_f32 v105, v105
    v_exp_f32 v106, v106
    v_exp_f32 v107, v107
    v_exp_f32 v108, v108
    v_exp_f32 v109, v109
    v_exp_f32 v110, v110
    v_exp_f32 v111, v111
    v_cvt_pk_bf16_f32 v96, v96, v97
    v_cvt_pk_bf16_f32 v97, v98, v99
    v_cvt_pk_bf16_f32 v98, v100, v101
    v_cvt_pk_bf16_f32 v99, v102, v103
    v_cvt_pk_bf16_f32 v100, v104, v105
    v_cvt_pk_bf16_f32 v101, v106, v107
    v_cvt_pk_bf16_f32 v102, v108, v109
    v_cvt_pk_bf16_f32 v103, v110, v111
    s_cmp_eq_u32 s57, 4
    s_cbranch_scc1 k2_pvx4
    s_waitcnt lgkmcnt(0)
    v_mfma_f32_32x32x16_bf16 v[160:175], v[180:183], v[96:99], v[160:175]
    s_mov_b64 exec, s[92:93]
    ds_read_b128 v[188:191], v206 offset:9504
    ds_read_b128 v[192:195], v206 offset:10656
    s_mov_b64 exec, -1
    v_exp_f32 v80, v80
    v_exp_f32 v81, v81
    v_exp_f32 v82, v82
    v_exp_f32 v83, v83
    v_mfma_f32_32x32x16_bf16 v[160:175], v[184:187], v[100:103], v[160:175]
    v_exp_f32 v84, v84
    v_exp_f32 v85, v85
    v_exp_f32 v86, v86
    v_exp_f32 v87, v87
    v_mfma_f32_32x32x16_bf16 v[48:63], v[236:239], v[248:251], v[48:63]
    v_exp_f32 v88, v88
    v_exp_f32 v89, v89
    v_exp_f32 v90, v90
    v_exp_f32 v91, v91
    v_exp_f32 v92, v92
    v_exp_f32 v93, v93
    v_exp_f32 v94, v94
    v_exp_f32 v95, v95
    v_cvt_pk_bf16_f32 v80, v80, v81
    v_cvt_pk_bf16_f32 v81, v82, v83
    v_cvt_pk_bf16_f32 v82, v84, v85
    v_cvt_pk_bf16_f32 v83, v86, v87
    v_cvt_pk_bf16_f32 v84, v88, v89
    v_cvt_pk_bf16_f32 v85, v90, v91
    v_cvt_pk_bf16_f32 v86, v92, v93
    v_cvt_pk_bf16_f32 v87, v94, v95
    s_cmp_eq_u32 s57, 5
    s_cbranch_scc1 k2_pvx5
    s_waitcnt lgkmcnt(0)
    v_mfma_f32_32x32x16_bf16 v[160:175], v[188:191], v[80:83], v[160:175]
    s_mov_b64 exec, s[92:93]
    ds_read_b128 v[180:183], v206 offset:7200
    ds_read_b128 v[184:187], v206 offset:8352
    s_mov_b64 exec, -1
    v_exp_f32 v64, v64
    v_exp_f32 v65, v65
    v_exp_f32 v66, v66
    v_exp_f32 v67, v67
    v_mfma_f32_32x32x16_bf16 v[160:175], v[192:195], v[84:87], v[160:175]
    v_exp_f32 v68, v68
    v_exp_f32 v69, v69
    v_exp_f32 v70, v70
    v_exp_f32 v71, v71
    v_mfma_f32_32x32x16_bf16 v[32:47], v[236:239], v[248:251], v[32:47]
    v_exp_f32 v72, v72
    v_exp_f32 v73, v73
    v_exp_f32 v74, v74
    v_exp_f32 v75, v75
    v_exp_f32 v76, v76
    v_exp_f32 v77, v77
    v_exp_f32 v78, v78
    v_exp_f32 v79, v79
    v_cvt_pk_bf16_f32 v64, v64, v65
    v_cvt_pk_bf16_f32 v65, v66, v67
    v_cvt_pk_bf16_f32 v66, v68, v69
    v_cvt_pk_bf16_f32 v67, v70, v71
    v_cvt_pk_bf16_f32 v68, v72, v73
    v_cvt_pk_bf16_f32 v69, v74, v75
    v_cvt_pk_bf16_f32 v70, v76, v77
    v_cvt_pk_bf16_f32 v71, v78, v79
    s_cmp_eq_u32 s57, 6
    s_cbranch_scc1 k2_pvx6
    s_waitcnt lgkmcnt(0)
    v_mfma_f32_32x32x16_bf16 v[160:175], v[180:183], v[64:67], v[160:175]
    s_mov_b64 exec, s[92:93]
    ds_read_b128 v[188:191], v206 offset:4896
    ds_read_b128 v[192:195], v206 offset:6048
    s_mov_b64 exec, -1
    v_exp_f32 v48, v48
    v_exp_f32 v49, v49
    v_exp_f32 v50, v50
    v_exp_f32 v51, v51
    v_mfma_f32_32x32x16_bf16 v[160:175], v[184:187], v[68:71], v[160:175]
    v_exp_f32 v52, v52
    v_exp_f32 v53, v53
    v_exp_f32 v54, v54
    v_exp_f32 v55, v55
    v_exp_f32 v56, v56
    v_exp_f32 v57, v57
    v_exp_f32 v58, v58
    v_exp_f32 v59, v59
    v_exp_f32 v60, v60
    v_exp_f32 v61, v61
    v_exp_f32 v62, v62
    v_exp_f32 v63, v63
    v_cvt_pk_bf16_f32 v48, v48, v49
    v_cvt_pk_bf16_f32 v49, v50, v51
    v_cvt_pk_bf16_f32 v50, v52, v53
    v_cvt_pk_bf16_f32 v51, v54, v55
    v_cvt_pk_bf16_f32 v52, v56, v57
    v_cvt_pk_bf16_f32 v53, v58, v59
    v_cvt_pk_bf16_f32 v54, v60, v61
    v_cvt_pk_bf16_f32 v55, v62, v63
    s_cmp_eq_u32 s57, 7
    s_cbranch_scc1 k2_pvx7
    s_waitcnt lgkmcnt(0)
    v_mfma_f32_32x32x16_bf16 v[160:175], v[188:191], v[48:51], v[160:175]
    s_mov_b64 exec, s[92:93]
    ds_read_b128 v[180:183], v206 offset:2592
    ds_read_b128 v[184:187], v206 offset:3744
    s_mov_b64 exec, -1
    v_exp_f32 v32, v32
    v_exp_f32 v33, v33
    v_exp_f32 v34, v34
    v_exp_f32 v35, v35
    v_mfma_f32_32x32x16_bf16 v[160:175], v[192:195], v[52:55], v[160:175]
    v_exp_f32 v36, v36
    v_exp_f32 v37, v37
    v_exp_f32 v38, v38
    v_exp_f32 v39, v39
    v_exp_f32 v40, v40
    v_exp_f32 v41, v41
    v_exp_f32 v42, v42
    v_exp_f32 v43, v43
    v_exp_f32 v44, v44
    v_exp_f32 v45, v45
    v_exp_f32 v46, v46
    v_exp_f32 v47, v47
    v_cvt_pk_bf16_f32 v32, v32, v33
    v_cvt_pk_bf16_f32 v33, v34, v35
    v_cvt_pk_bf16_f32 v34, v36, v37
    v_cvt_pk_bf16_f32 v35, v38, v39
    v_cvt_pk_bf16_f32 v36, v40, v41
    v_cvt_pk_bf16_f32 v37, v42, v43
    v_cvt_pk_bf16_f32 v38, v44, v45
    v_cvt_pk_bf16_f32 v39, v46, v47
    s_waitcnt lgkmcnt(0)
    v_mfma_f32_32x32x16_bf16 v[160:175], v[180:183], v[32:35], v[160:175]
    v_mfma_f32_32x32x16_bf16 v[160:175], v[184:187], v[36:39], v[160:175]
    s_branch k2_pvdone
k2_pvx1:
    s_waitcnt lgkmcnt(0)
    v_mfma_f32_32x32x16_bf16 v[160:175], v[180:183], v[144:147], 0
    v_mfma_f32_32x32x16_bf16 v[160:175], v[184:187], v[148:151], v[160:175]
    v_mfma_f32_32x32x16_bf16 v[160:175], v[188:191], v[16:19], v[160:175]
    v_mfma_f32_32x32x16_bf16 v[160:175], v[192:195], v[20:23], v[160:175]
    s_branch k2_pvdone
k2_pvx2:
    s_waitcnt lgkmcnt(0)
    v_mfma_f32_32x32x16_bf16 v[160:175], v[180:183], v[128:131], v[160:175]
    v_mfma_f32_32x32x16_bf16 v[160:175], v[184:187], v[132:135], v[160:175]
    s_branch k2_pvdone
k2_pvx3:
    s_waitcnt lgkmcnt(0)
    v_mfma_f32_32x32x16_bf16 v[160:175], v[188:191], v[112:115], v[160:175]
    v_mfma_f32_32x32x16_bf16 v[160:175], v[192:195], v[116:119], v[160:175]
    s_branch k2_pvdone
k2_pvx4:
    s_waitcnt lgkmcnt(0)
    v_mfma_f32_32x32x16_bf16 v[160:175], v[180:183], v[96:99], v[160:175]
    v_mfma_f32_32x32x16_bf16 v[160:175], v[184:187], v[100:103], v[160:175]
    s_branch k2_pvdone
k2_pvx5:
    s_waitcnt lgkmcnt(0)
    v_mfma_f32_32x32x16_bf16 v[160:175], v[188:191], v[80:83], v[160:175]
    v_mfma_f32_32x32x16_bf16 v[160:175], v[192:195], v[84:87], v[160:175]
    s_branch k2_pvdone
k2_pvx6:
    s_waitcnt lgkmcnt(0)
    v_mfma_f32_32x32x16_bf16 v[160:175], v[180:183], v[64:67], v[160:175]
    v_mfma_f32_32x32x16_bf16 v[160:175], v[184:187], v[68:71], v[160:175]
    s_branch k2_pvdone
k2_pvx7:
    s_waitcnt lgkmcnt(0)
    v_mfma_f32_32x32x16_bf16 v[160:175], v[188:191], v[48:51], v[160:175]
    v_mfma_f32_32x32x16_bf16 v[160:175], v[192:195], v[52:55], v[160:175]
k2_pvdone:
    s_lshl_b32 s51, s44, 16
    s_lshl_b32 s50, s44, 13
    s_add_u32 s50, s50, 2097152
    s_lshl_b32 s52, s45, 3
    s_add_u32 s52, s52, s48
    s_lshl_b32 s52, s52, 5
    s_add_u32 s52, s52, s44
    s_lshl_b32 s52, s52, 5
    s_add_u32 s52, s52, 393216
    s_nop 2
    v_rcp_f32 v2, v170
    v_lshrrev_b32 v3, 2, v211
    v_mul_f32 v160, v160, v2
    v_mul_f32 v161, v161, v2
    v_mul_f32 v162, v162, v2
    v_mul_f32 v163, v163, v2
    v_mul_f32 v164, v164, v2
    v_mul_f32 v165, v165, v2
    v_mul_f32 v166, v166, v2
    v_mul_f32 v167, v167, v2
    v_mul_f32 v168, v168, v2
    v_mul_f32 v169, v169, v2
    v_cvt_pk_bf16_f32 v228, v168, v169
    v_cvt_pk_bf16_f32 v224, v160, v161
    v_cvt_pk_bf16_f32 v225, v162, v163
    v_cvt_pk_bf16_f32 v226, v164, v165
    v_cvt_pk_bf16_f32 v227, v166, v167
    v_mov_b32_dpp v229, v228 quad_perm:[1,1,1,1] row_mask:0xf bank_mask:0xf
    v_mov_b32_dpp v230, v228 quad_perm:[2,2,2,2] row_mask:0xf bank_mask:0xf
    v_mov_b32_dpp v231, v228 quad_perm:[3,3,3,3] row_mask:0xf bank_mask:0xf
    buffer_store_dwordx4 v[224:227], v210, s[24:27], s51 offen sc1
    s_mov_b32 exec_lo, 0x11111111
    s_mov_b32 exec_hi, 0
    buffer_store_dwordx4 v[228:231], v3, s[24:27], s50 offen sc1
    s_mov_b64 exec, -1
    s_mov_b32 s59, s52
    s_branch k2_attn2
k2_end:
    s_cmp_eq_u32 s59, 0
    s_cbranch_scc1 f_pb
    s_waitcnt vmcnt(0)
    v_mov_b32 v10, s100
    v_mov_b32 v11, s101
    v_mov_b32 v12, 0
    s_mov_b64 exec, 1
    buffer_store_dwordx2 v[10:11], v12, s[32:35], s59 offen sc1
    s_mov_b64 exec, -1
    s_mov_b32 s59, 0
f_pb:
    s_setprio 0
    s_mov_b32 s51, 1048576
f_cdone:
    ds_read_b32 v6, v255 offset:60
    s_sub_u32 s51, s51, 1
    s_cbranch_scc1 f_cdone_x
    s_waitcnt lgkmcnt(0)
    v_readfirstlane_b32 s50, v6
    s_cmp_ge_u32 s50, 4
    s_cbranch_scc1 f_cdone_x
    s_sleep 1
    s_branch f_cdone
f_cdone_x:
f_wor:
    s_load_dwordx2 s[40:41], s[0:1], 0
    s_load_dwordx2 s[42:43], s[0:1], 16
    s_and_b32 s50, s2, 6
    s_lshl_b32 s36, s50, 8
    s_lshr_b32 s50, s2, 5
    s_lshl_b32 s50, s50, 6
    s_add_u32 s36, s36, s50
    s_and_b32 s50, s2, 1
    s_lshl_b32 s37, s50, 2
    s_bfe_u32 s50, s2, 0x20003
    s_add_u32 s37, s37, s50
    s_mul_i32 s53, s37, 144
    s_waitcnt lgkmcnt(0)
    s_mov_b32 s8, s42
    s_and_b32 s9, s43, 0xffff
    s_mov_b32 s10, 663552
    s_mov_b32 s11, 0x00020000
    s_mov_b32 s12, s40
    s_and_b32 s13, s41, 0xffff
    s_mov_b32 s14, 2359296
    s_mov_b32 s15, 0x00020000
p3_wq:
    v_mov_b32 v2, 1
    s_mov_b64 exec, 1
    ds_add_rtn_u32 v3, v255, v2 offset:96
    s_mov_b64 exec, -1
    s_waitcnt lgkmcnt(0)
    v_readfirstlane_b32 s39, v3
    s_cmp_ge_u32 s39, 8
    s_cbranch_scc1 p3_wqx
    s_mul_i32 s50, s39, 41472
    s_mul_i32 s51, s39, 5120
    s_add_u32 s51, s51, 46080
    s_add_u32 s52, s50, 331776
    v_mov_b32 v5, v1
    s_mov_b32 s38, 0
p3_wloop:
    v_mul_u32_u24 v6, 6554, v5
    v_lshrrev_b32 v6, 16, v6
    v_mul_u32_u24 v7, 10, v6
    v_sub_u32 v7, v5, v7
    v_lshl_add_u32 v176, v7, 4, s53
    v_and_b32 v7, 0x13, v6
    v_bfe_u32 v8, v6, 2, 1
    v_lshl_or_b32 v7, v8, 3, v7
    v_bfe_u32 v8, v6, 3, 1
    v_lshl_or_b32 v7, v8, 2, v7
    v_lshrrev_b32 v8, 4, v7
    v_lshl_add_u32 v7, v8, 1, v7
    v_mov_b32 v8, 1152
    v_mad_u32_u24 v176, v7, v8, v176
    s_mov_b32 m0, s51
    v_add_u32 v5, 64, v5
    s_cmp_eq_u32 s46, 0
    s_cbranch_scc1 p3_wsk
    buffer_load_dwordx4 v176, s[8:11], s50 offen lds
p3_wsk:
    s_add_u32 m0, s51, 46080
    s_add_u32 s51, s51, 1024
    buffer_load_dwordx4 v176, s[8:11], s52 offen lds
    s_add_u32 s38, s38, 1
    s_cmp_lt_u32 s38, 5
    s_cbranch_scc1 p3_wloop
    s_cmp_lt_u32 s39, 3
    s_cbranch_scc1 p3_x
    s_sub_u32 s38, s39, 3
    s_lshl_b32 s50, s38, 6
    v_add_u32 v5, s50, v1
    v_mul_u32_u24 v6, 6554, v5
    v_lshrrev_b32 v6, 16, v6
    v_mul_u32_u24 v7, 10, v6
    v_sub_u32 v7, v5, v7
    v_lshl_add_u32 v176, v7, 4, s53
    v_and_b32 v7, 0x13, v6
    v_bfe_u32 v8, v6, 2, 1
    v_lshl_or_b32 v7, v8, 3, v7
    v_bfe_u32 v8, v6, 3, 1
    v_lshl_or_b32 v7, v8, 2, v7
    v_lshrrev_b32 v8, 1, v7
    v_lshlrev_b32 v8, 4, v8
    v_add3_u32 v7, v7, v8, 16
    v_mov_b32 v8, 1152
    v_mad_u32_u24 v176, v7, v8, v176
    s_lshl_b32 s50, s38, 10
    s_add_u32 m0, s50, 87040
    s_mov_b32 s51, 331776
    buffer_load_dwordx4 v176, s[8:11], 0 offen lds
    s_add_u32 m0, s50, 133120
    s_nop 0
    buffer_load_dwordx4 v176, s[8:11], s51 offen lds
    s_branch p3_nox
p3_x:
    s_mov_b32 s50, s39
    s_mul_i32 s38, s50, 3072
    s_mul_i32 s50, s50, 192
    v_add_u32 v5, s50, v1
    s_mul_i32 s51, s36, 1152
    s_add_u32 s51, s51, s53
    v_mul_u32_u24 v6, 7282, v5
    v_lshrrev_b32 v6, 16, v6
    v_mul_u32_u24 v6, 1008, v6
    v_lshl_add_u32 v6, v5, 4, v6
    s_add_u32 m0, s38, 138240
    v_add_u32 v5, 64, v5
    buffer_load_dwordx4 v6, s[12:15], s51 offen lds
    v_mul_u32_u24 v6, 7282, v5
    v_lshrrev_b32 v6, 16, v6
    v_mul_u32_u24 v6, 1008, v6
    v_lshl_add_u32 v6, v5, 4, v6
    s_add_u32 m0, s38, 139264
    v_add_u32 v5, 64, v5
    buffer_load_dwordx4 v6, s[12:15], s51 offen lds
    v_mul_u32_u24 v6, 7282, v5
    v_lshrrev_b32 v6, 16, v6
    v_mul_u32_u24 v6, 1008, v6
    v_lshl_add_u32 v6, v5, 4, v6
    s_add_u32 m0, s38, 140288
    v_add_u32 v5, 64, v5
    buffer_load_dwordx4 v6, s[12:15], s51 offen lds
p3_nox:
    s_branch p3_wq
p3_wqx:
    s_load_dwordx2 s[64:65], s[0:1], 80
    s_and_b32 s50, s2, 6
    s_lshl_b32 s44, s50, 8
    s_lshr_b32 s50, s2, 5
    s_lshl_b32 s50, s50, 6
    s_add_u32 s44, s44, s50
    s_and_b32 s50, s2, 1
    s_lshl_b32 s45, s50, 2
    s_bfe_u32 s50, s2, 0x20003
    s_add_u32 s45, s45, s50
    s_and_b32 s46, s3, 1
    s_lshr_b32 s47, s3, 1
    s_mul_i32 s53, s45, 144
    s_add_u32 s8, s4, 16777216
    s_addc_u32 s9, s5, 0
    s_and_b32 s9, s9, 0xffff
    s_mov_b32 s10, 2359296
    s_mov_b32 s11, 0x00020000
    s_add_u32 s24, s4, 25264128
    s_addc_u32 s25, s5, 0
    s_and_b32 s25, s25, 0xffff
    s_mov_b32 s26, 16384
    s_mov_b32 s27, 0x00020000
    s_add_u32 s20, s4, 12582912
    s_addc_u32 s21, s5, 0
    s_and_b32 s21, s21, 0xffff
    s_mov_b32 s22, 2359296
    s_mov_b32 s23, 0x00020000
    v_and_b32 v2, 15, v1
    v_lshrrev_b32 v3, 4, v1
    s_lshl_b32 s50, s47, 4
    s_add_u32 s51, s50, s44
    v_add_u32 v4, s51, v2
    v_lshlrev_b32 v5, 15, v3
    v_lshl_add_u32 v18, v4, 4, v5
    v_lshl_add_u32 v19, v4, 2, v5
    v_lshlrev_b32 v14, 3, v4
    s_mul_i32 s54, s51, 1152
    s_add_u32 s54, s54, s53
    s_lshr_b32 s51, s51, 5
    s_lshl_b32 s51, s51, 5
    s_lshl_b32 s52, s46, 4
    s_add_u32 s51, s51, s52
    s_lshl_b32 s51, s51, 5
    s_add_u32 s51, s51, 393216
    v_lshl_add_u32 v20, v1, 5, s51
    s_mov_b32 s55, 0
    s_mov_b32 s56, 0
    s_mov_b32 s57, 0
    s_lshl_b32 s43, s46, 20
    s_mov_b32 s49, 65536
    s_mov_b32 s42, 1
    s_branch p3_prep
p3_loop:
    s_cmp_eq_u32 s55, 0xffff
    s_cbranch_scc1 p3_nofl
    s_andn2_b32 exec_lo, 0xffff, s55
    s_mov_b32 exec_hi, 0
    buffer_load_dwordx2 v[212:213], v20, s[32:35], 0 offen sc1
p3_chk:
    s_waitcnt vmcnt(0)
    v_cmp_eq_u64 vcc, s[100:101], v[212:213]
    s_mov_b64 exec, -1
    s_nop 0
    s_or_b32 s55, s55, vcc_lo
p3_nofl:
    s_waitcnt vmcnt(0) lgkmcnt(0)
    s_andn2_b32 s48, s56, s57
    s_mov_b32 s57, s56
    s_lshr_b32 s50, s55, 1
    s_and_b32 s50, s50, s55
    s_and_b32 s50, s50, 0x5555
    s_cmp_eq_u32 s55, 0xffff
    s_cselect_b32 s51, 0x10000, 0
    s_or_b32 s50, s50, s51
    s_sub_u32 s49, s49, 1
    s_cselect_b32 s50, 0x15555, s50
    s_andn2_b32 s59, s50, s56
    s_or_b32 s56, s56, s59
    s_bitcmp0_b32 s59, 0
    s_cbranch_scc1 p3_l0
    s_add_u32 s50, s43, 0
    buffer_load_dwordx4 v[34:37], v18, s[8:11], s50 offen sc1
p3_l0:
    s_bitcmp0_b32 s59, 2
    s_cbranch_scc1 p3_l1
    s_add_u32 s50, s43, 131072
    buffer_load_dwordx4 v[38:41], v18, s[8:11], s50 offen sc1
p3_l1:
    s_bitcmp0_b32 s59, 4
    s_cbranch_scc1 p3_l2
    s_add_u32 s50, s43, 262144
    buffer_load_dwordx4 v[42:45], v18, s[8:11], s50 offen sc1
p3_l2:
    s_bitcmp0_b32 s59, 6
    s_cbranch_scc1 p3_l3
    s_add_u32 s50, s43, 393216
    buffer_load_dwordx4 v[46:49], v18, s[8:11], s50 offen sc1
p3_l3:
    s_bitcmp0_b32 s59, 8
    s_cbranch_scc1 p3_l4
    s_add_u32 s50, s43, 524288
    buffer_load_dwordx4 v[50:53], v18, s[8:11], s50 offen sc1
p3_l4:
    s_bitcmp0_b32 s59, 10
    s_cbranch_scc1 p3_l5
    s_add_u32 s50, s43, 655360
    buffer_load_dwordx4 v[54:57], v18, s[8:11], s50 offen sc1
p3_l5:
    s_bitcmp0_b32 s59, 12
    s_cbranch_scc1 p3_l6
    s_add_u32 s50, s43, 786432
    buffer_load_dwordx4 v[58:61], v18, s[8:11], s50 offen sc1
p3_l6:
    s_bitcmp0_b32 s59, 14
    s_cbranch_scc1 p3_l7
    s_add_u32 s50, s43, 917504
    buffer_load_dwordx4 v[62:65], v18, s[8:11], s50 offen sc1
p3_l7:
    s_bitcmp0_b32 s59, 16
    s_cbranch_scc1 p3_l8
    s_lshr_b32 s50, s43, 3
    s_add_u32 s50, s50, 2097152
    buffer_load_dword v66, v19, s[8:11], s50 offen sc1
    s_add_u32 s50, s50, 8192
    buffer_load_dword v67, v19, s[8:11], s50 offen sc1
    s_add_u32 s50, s50, 8192
    buffer_load_dword v68, v19, s[8:11], s50 offen sc1
    s_add_u32 s50, s50, 8192
    buffer_load_dword v69, v19, s[8:11], s50 offen sc1
p3_l8:
    s_cmp_eq_u32 s42, 0
    s_cbranch_scc1 p3_mm
    s_branch p3_post
p3_prep:
    s_mov_b32 s42, 0
    s_cmp_lt_u32 s3, 5
    s_cbranch_scc1 p3_ld
    s_sub_u32 s50, s3, 5
    s_mul_i32 s51, s50, 24
    s_mul_i32 s52, s45, 72
    s_add_u32 s52, s52, s51
    s_mul_i32 s58, s50, 3072
    s_lshl_b32 s50, s52, 7
    s_add_u32 s50, s50, 262144
    v_lshl_add_u32 v10, v1, 7, s50
    s_mov_b64 exec, 0xffffff
    s_mov_b32 s51, 65536
p3_pollz:
    buffer_load_dwordx2 v[12:13], v10, s[32:35], 0 offen sc1
    s_sub_u32 s51, s51, 1
    s_cbranch_scc1 p3_pollz_x
    s_waitcnt vmcnt(0)
    v_cmp_ne_u64 vcc, s[100:101], v[12:13]
    s_cbranch_vccz p3_pollz_x
    s_mov_b64 exec, vcc
    s_sleep 4
    s_branch p3_pollz
p3_pollz_x:
    s_mov_b64 exec, -1
    s_mov_b32 s51, 1048576
p3_cdone:
    ds_read_b32 v6, v255 offset:60
    s_sub_u32 s51, s51, 1
    s_cbranch_scc1 p3_cdone_x
    s_waitcnt lgkmcnt(0)
    v_readfirstlane_b32 s50, v6
    s_cmp_ge_u32 s50, 4
    s_cbranch_scc1 p3_cdone_x
    s_sleep 1
    s_branch p3_cdone
p3_cdone_x:
    v_lshrrev_b32 v6, 3, v1
    v_add_u32 v6, s52, v6
    v_lshlrev_b32 v6, 12, v6
    v_and_b32 v7, 7, v1
    v_lshl_add_u32 v6, v7, 4, v6
    s_lshl_b32 s50, s44, 1
    s_add_u32 m0, s58, 147456
    s_add_u32 s51, s50, 0
    buffer_load_dwordx4 v6, s[20:23], s51 offen sc1 lds
    s_add_u32 m0, s58, 148480
    s_add_u32 s51, s50, 32768
    buffer_load_dwordx4 v6, s[20:23], s51 offen sc1 lds
    s_add_u32 m0, s58, 149504
    s_add_u32 s51, s50, 65536
    buffer_load_dwordx4 v6, s[20:23], s51 offen sc1 lds
p3_ld:
    v_and_b32 v2, 15, v1
    v_lshrrev_b32 v3, 4, v1
    s_lshl_b32 s50, s47, 4
    v_add_u32 v4, s50, v2
    v_mul_u32_u24 v4, 144, v4
    v_lshl_add_u32 v4, v3, 3, v4
    v_add_u32 v21, 138240, v4
    v_lshrrev_b32 v4, 2, v1
    v_lshlrev_b32 v4, 7, v4
    v_and_b32 v5, 3, v1
    v_lshl_add_u32 v4, v5, 3, v4
    s_lshl_b32 s50, s47, 5
    s_add_u32 s50, s50, 147456
    v_add_u32 v11, s50, v4
    s_mul_i32 s50, s47, 5120
    v_lshl_add_u32 v22, v1, 4, s50
    v_lshrrev_b32 v2, 5, v1
    v_lshlrev_b32 v2, 4, v2
    v_bfe_u32 v3, v1, 4, 1
    v_lshl_add_u32 v2, v3, 2, v2
    v_bfe_u32 v3, v1, 2, 2
    v_add_u32 v2, v2, v3
    v_mul_u32_u24 v2, 160, v2
    v_lshl_add_u32 v2, v5, 3, v2
    s_mul_i32 s50, s46, 46080
    s_add_u32 s50, s50, 46080
    v_add_u32 v15, s50, v2
    v_mov_b64 v[70:71], 0
    v_mov_b64 v[72:73], 0
    v_mov_b64 v[74:75], 0
    v_mov_b64 v[76:77], 0
    v_mov_b64 v[78:79], 0
    v_mov_b64 v[80:81], 0
    v_mov_b64 v[82:83], 0
    v_mov_b64 v[84:85], 0
    v_mov_b64 v[86:87], 0
    v_mov_b64 v[88:89], 0
    s_waitcnt vmcnt(0) lgkmcnt(0)
    s_mov_b32 s28, s64
    s_and_b32 s29, s65, 0xffff
    s_mov_b32 s30, 2359296
    s_mov_b32 s31, 0x00020000
    s_barrier
    s_mov_b64 exec, 0xffff
    buffer_load_dwordx2 v[212:213], v20, s[32:35], 0 offen sc1
    s_mov_b64 exec, -1
    buffer_load_dwordx2 v[16:17], v14, s[24:27], 0 offen sc1
    ds_read_b64_tr_b16 v[90:91], v15 offset:0
    ds_read_b64_tr_b16 v[92:93], v15 offset:1280
    ds_read_b64_tr_b16 v[94:95], v15 offset:32
    ds_read_b64_tr_b16 v[96:97], v15 offset:1312
    ds_read_b64_tr_b16 v[98:99], v15 offset:64
    ds_read_b64_tr_b16 v[100:101], v15 offset:1344
    ds_read_b64_tr_b16 v[102:103], v15 offset:96
    ds_read_b64_tr_b16 v[104:105], v15 offset:1376
    ds_read_b64_tr_b16 v[106:107], v15 offset:128
    ds_read_b64_tr_b16 v[108:109], v15 offset:1408
    ds_read_b64_tr_b16 v[110:111], v15 offset:5120
    ds_read_b64_tr_b16 v[112:113], v15 offset:6400
    ds_read_b64_tr_b16 v[114:115], v15 offset:5152
    ds_read_b64_tr_b16 v[116:117], v15 offset:6432
    ds_read_b64_tr_b16 v[118:119], v15 offset:5184
    ds_read_b64_tr_b16 v[120:121], v15 offset:6464
    ds_read_b64_tr_b16 v[122:123], v15 offset:5216
    ds_read_b64_tr_b16 v[124:125], v15 offset:6496
    ds_read_b64_tr_b16 v[126:127], v15 offset:5248
    ds_read_b64_tr_b16 v[128:129], v15 offset:6528
    ds_read_b64_tr_b16 v[130:131], v15 offset:10240
    ds_read_b64_tr_b16 v[132:133], v15 offset:11520
    ds_read_b64_tr_b16 v[134:135], v15 offset:10272
    ds_read_b64_tr_b16 v[136:137], v15 offset:11552
    ds_read_b64_tr_b16 v[138:139], v15 offset:10304
    ds_read_b64_tr_b16 v[140:141], v15 offset:11584
    ds_read_b64_tr_b16 v[142:143], v15 offset:10336
    ds_read_b64_tr_b16 v[144:145], v15 offset:11616
    ds_read_b64_tr_b16 v[146:147], v15 offset:10368
    ds_read_b64_tr_b16 v[148:149], v15 offset:11648
    s_mov_b32 s42, 2
    s_mov_b64 exec, 0xffff
    s_branch p3_chk
p3_post:
    s_mov_b32 s42, 0
    ds_read_b64_tr_b16 v[150:151], v15 offset:15360
    ds_read_b64_tr_b16 v[152:153], v15 offset:16640
    ds_read_b64_tr_b16 v[154:155], v15 offset:15392
    ds_read_b64_tr_b16 v[156:157], v15 offset:16672
    ds_read_b64_tr_b16 v[158:159], v15 offset:15424
    ds_read_b64_tr_b16 v[160:161], v15 offset:16704
    ds_read_b64_tr_b16 v[162:163], v15 offset:15456
    ds_read_b64_tr_b16 v[164:165], v15 offset:16736
    ds_read_b64_tr_b16 v[166:167], v15 offset:15488
    ds_read_b64_tr_b16 v[168:169], v15 offset:16768
    ds_read_b64_tr_b16 v[170:171], v15 offset:20480
    ds_read_b64_tr_b16 v[172:173], v15 offset:21760
    ds_read_b64_tr_b16 v[174:175], v15 offset:20512
    ds_read_b64_tr_b16 v[176:177], v15 offset:21792
    ds_read_b64_tr_b16 v[178:179], v15 offset:20544
    ds_read_b64_tr_b16 v[180:181], v15 offset:21824
    ds_read_b64_tr_b16 v[182:183], v15 offset:20576
    ds_read_b64_tr_b16 v[184:185], v15 offset:21856
    ds_read_b64_tr_b16 v[186:187], v15 offset:20608
    ds_read_b64_tr_b16 v[188:189], v15 offset:21888
    ds_read_b64_tr_b16 v[190:191], v15 offset:25600
    ds_read_b64_tr_b16 v[192:193], v15 offset:26880
    ds_read_b64_tr_b16 v[194:195], v15 offset:25632
    ds_read_b64_tr_b16 v[196:197], v15 offset:26912
    ds_read_b64_tr_b16 v[198:199], v15 offset:25664
    ds_read_b64_tr_b16 v[200:201], v15 offset:26944
    ds_read_b64_tr_b16 v[202:203], v15 offset:25696
    ds_read_b64_tr_b16 v[204:205], v15 offset:26976
    ds_read_b64_tr_b16 v[206:207], v15 offset:25728
    ds_read_b64_tr_b16 v[208:209], v15 offset:27008
    s_cmp_eq_u32 s46, 1
    s_cbranch_scc1 p3_nob
    ds_read_b64 v[224:225], v21 offset:0
    ds_read_b64_tr_b16 v[234:235], v11 offset:0
    ds_read_b64 v[226:227], v21 offset:32
    ds_read_b64_tr_b16 v[236:237], v11 offset:2048
    ds_read_b64 v[228:229], v21 offset:64
    ds_read_b64_tr_b16 v[238:239], v11 offset:4096
    ds_read_b64 v[230:231], v21 offset:96
    ds_read_b64_tr_b16 v[240:241], v11 offset:6144
    ds_read_b64 v[232:233], v21 offset:128
    ds_read_b64_tr_b16 v[242:243], v11 offset:8192
    s_waitcnt lgkmcnt(0)
    v_lshlrev_b32 v6, 16, v224
    v_and_b32 v7, 0xffff0000, v224
    v_lshlrev_b32 v8, 16, v234
    v_and_b32 v9, 0xffff0000, v234
    v_pk_mul_f32 v[6:7], v[6:7], v[8:9]
    v_cvt_pk_bf16_f32 v24, v6, v7
    v_lshlrev_b32 v6, 16, v225
    v_and_b32 v7, 0xffff0000, v225
    v_lshlrev_b32 v8, 16, v235
    v_and_b32 v9, 0xffff0000, v235
    v_pk_mul_f32 v[6:7], v[6:7], v[8:9]
    v_cvt_pk_bf16_f32 v25, v6, v7
    v_lshlrev_b32 v6, 16, v226
    v_and_b32 v7, 0xffff0000, v226
    v_lshlrev_b32 v8, 16, v236
    v_and_b32 v9, 0xffff0000, v236
    v_pk_mul_f32 v[6:7], v[6:7], v[8:9]
    v_cvt_pk_bf16_f32 v26, v6, v7
    v_lshlrev_b32 v6, 16, v227
    v_and_b32 v7, 0xffff0000, v227
    v_lshlrev_b32 v8, 16, v237
    v_and_b32 v9, 0xffff0000, v237
    v_pk_mul_f32 v[6:7], v[6:7], v[8:9]
    v_cvt_pk_bf16_f32 v27, v6, v7
    v_lshlrev_b32 v6, 16, v228
    v_and_b32 v7, 0xffff0000, v228
    v_lshlrev_b32 v8, 16, v238
    v_and_b32 v9, 0xffff0000, v238
    v_pk_mul_f32 v[6:7], v[6:7], v[8:9]
    v_cvt_pk_bf16_f32 v28, v6, v7
    v_lshlrev_b32 v6, 16, v229
    v_and_b32 v7, 0xffff0000, v229
    v_lshlrev_b32 v8, 16, v239
    v_and_b32 v9, 0xffff0000, v239
    v_pk_mul_f32 v[6:7], v[6:7], v[8:9]
    v_cvt_pk_bf16_f32 v29, v6, v7
    v_lshlrev_b32 v6, 16, v230
    v_and_b32 v7, 0xffff0000, v230
    v_lshlrev_b32 v8, 16, v240
    v_and_b32 v9, 0xffff0000, v240
    v_pk_mul_f32 v[6:7], v[6:7], v[8:9]
    v_cvt_pk_bf16_f32 v30, v6, v7
    v_lshlrev_b32 v6, 16, v231
    v_and_b32 v7, 0xffff0000, v231
    v_lshlrev_b32 v8, 16, v241
    v_and_b32 v9, 0xffff0000, v241
    v_pk_mul_f32 v[6:7], v[6:7], v[8:9]
    v_cvt_pk_bf16_f32 v31, v6, v7
    v_lshlrev_b32 v6, 16, v232
    v_and_b32 v7, 0xffff0000, v232
    v_lshlrev_b32 v8, 16, v242
    v_and_b32 v9, 0xffff0000, v242
    v_pk_mul_f32 v[6:7], v[6:7], v[8:9]
    v_cvt_pk_bf16_f32 v32, v6, v7
    v_lshlrev_b32 v6, 16, v233
    v_and_b32 v7, 0xffff0000, v233
    v_lshlrev_b32 v8, 16, v243
    v_and_b32 v9, 0xffff0000, v243
    v_pk_mul_f32 v[6:7], v[6:7], v[8:9]
    v_cvt_pk_bf16_f32 v33, v6, v7
p3_nob:
    s_cmp_lg_u32 s59, 0x15555
    s_cbranch_scc1 p3_loop
    ds_read_b64_tr_b16 v[224:225], v15 offset:30720
    ds_read_b64_tr_b16 v[226:227], v15 offset:32000
    ds_read_b64_tr_b16 v[228:229], v15 offset:30752
    ds_read_b64_tr_b16 v[230:231], v15 offset:32032
    ds_read_b64_tr_b16 v[232:233], v15 offset:30784
    ds_read_b64_tr_b16 v[234:235], v15 offset:32064
    ds_read_b64_tr_b16 v[236:237], v15 offset:30816
    ds_read_b64_tr_b16 v[238:239], v15 offset:32096
    ds_read_b64_tr_b16 v[240:241], v15 offset:30848
    ds_read_b64_tr_b16 v[242:243], v15 offset:32128
    s_waitcnt vmcnt(11) lgkmcnt(0)
    v_mfma_f32_16x16x32_bf16 v[70:73], v[90:93], v[34:37], v[70:73]
    v_mfma_f32_16x16x32_bf16 v[74:77], v[94:97], v[34:37], v[74:77]
    v_mfma_f32_16x16x32_bf16 v[78:81], v[98:101], v[34:37], v[78:81]
    v_mfma_f32_16x16x32_bf16 v[82:85], v[102:105], v[34:37], v[82:85]
    v_mfma_f32_16x16x32_bf16 v[86:89], v[106:109], v[34:37], v[86:89]
    s_waitcnt vmcnt(10) lgkmcnt(15)
    v_mfma_f32_16x16x32_bf16 v[70:73], v[110:113], v[38:41], v[70:73]
    v_mfma_f32_16x16x32_bf16 v[74:77], v[114:117], v[38:41], v[74:77]
    v_mfma_f32_16x16x32_bf16 v[78:81], v[118:121], v[38:41], v[78:81]
    v_mfma_f32_16x16x32_bf16 v[82:85], v[122:125], v[38:41], v[82:85]
    v_mfma_f32_16x16x32_bf16 v[86:89], v[126:129], v[38:41], v[86:89]
    ds_read_b64_tr_b16 v[90:91], v15 offset:35840
    ds_read_b64_tr_b16 v[92:93], v15 offset:37120
    ds_read_b64_tr_b16 v[94:95], v15 offset:35872
    ds_read_b64_tr_b16 v[96:97], v15 offset:37152
    ds_read_b64_tr_b16 v[98:99], v15 offset:35904
    ds_read_b64_tr_b16 v[100:101], v15 offset:37184
    ds_read_b64_tr_b16 v[102:103], v15 offset:35936
    ds_read_b64_tr_b16 v[104:105], v15 offset:37216
    ds_read_b64_tr_b16 v[106:107], v15 offset:35968
    ds_read_b64_tr_b16 v[108:109], v15 offset:37248
    s_waitcnt vmcnt(9) lgkmcnt(15)
    v_mfma_f32_16x16x32_bf16 v[70:73], v[130:133], v[42:45], v[70:73]
    v_mfma_f32_16x16x32_bf16 v[74:77], v[134:137], v[42:45], v[74:77]
    v_mfma_f32_16x16x32_bf16 v[78:81], v[138:141], v[42:45], v[78:81]
    v_mfma_f32_16x16x32_bf16 v[82:85], v[142:145], v[42:45], v[82:85]
    v_mfma_f32_16x16x32_bf16 v[86:89], v[146:149], v[42:45], v[86:89]
    ds_read_b64_tr_b16 v[110:111], v15 offset:40960
    ds_read_b64_tr_b16 v[112:113], v15 offset:42240
    ds_read_b64_tr_b16 v[114:115], v15 offset:40992
    ds_read_b64_tr_b16 v[116:117], v15 offset:42272
    ds_read_b64_tr_b16 v[118:119], v15 offset:41024
    ds_read_b64_tr_b16 v[120:121], v15 offset:42304
    ds_read_b64_tr_b16 v[122:123], v15 offset:41056
    ds_read_b64_tr_b16 v[124:125], v15 offset:42336
    ds_read_b64_tr_b16 v[126:127], v15 offset:41088
    ds_read_b64_tr_b16 v[128:129], v15 offset:42368
    s_waitcnt vmcnt(8) lgkmcnt(15)
    v_mfma_f32_16x16x32_bf16 v[70:73], v[150:153], v[46:49], v[70:73]
    v_mfma_f32_16x16x32_bf16 v[74:77], v[154:157], v[46:49], v[74:77]
    v_mfma_f32_16x16x32_bf16 v[78:81], v[158:161], v[46:49], v[78:81]
    v_mfma_f32_16x16x32_bf16 v[82:85], v[162:165], v[46:49], v[82:85]
    v_mfma_f32_16x16x32_bf16 v[86:89], v[166:169], v[46:49], v[86:89]
    s_waitcnt vmcnt(7) lgkmcnt(15)
    v_mfma_f32_16x16x32_bf16 v[70:73], v[170:173], v[50:53], v[70:73]
    v_mfma_f32_16x16x32_bf16 v[74:77], v[174:177], v[50:53], v[74:77]
    v_mfma_f32_16x16x32_bf16 v[78:81], v[178:181], v[50:53], v[78:81]
    v_mfma_f32_16x16x32_bf16 v[82:85], v[182:185], v[50:53], v[82:85]
    v_mfma_f32_16x16x32_bf16 v[86:89], v[186:189], v[50:53], v[86:89]
    s_waitcnt vmcnt(6) lgkmcnt(15)
    v_mfma_f32_16x16x32_bf16 v[70:73], v[190:193], v[54:57], v[70:73]
    v_mfma_f32_16x16x32_bf16 v[74:77], v[194:197], v[54:57], v[74:77]
    v_mfma_f32_16x16x32_bf16 v[78:81], v[198:201], v[54:57], v[78:81]
    v_mfma_f32_16x16x32_bf16 v[82:85], v[202:205], v[54:57], v[82:85]
    v_mfma_f32_16x16x32_bf16 v[86:89], v[206:209], v[54:57], v[86:89]
    s_waitcnt vmcnt(5) lgkmcnt(15)
    v_mfma_f32_16x16x32_bf16 v[70:73], v[224:227], v[58:61], v[70:73]
    v_mfma_f32_16x16x32_bf16 v[74:77], v[228:231], v[58:61], v[74:77]
    v_mfma_f32_16x16x32_bf16 v[78:81], v[232:235], v[58:61], v[78:81]
    v_mfma_f32_16x16x32_bf16 v[82:85], v[236:239], v[58:61], v[82:85]
    v_mfma_f32_16x16x32_bf16 v[86:89], v[240:243], v[58:61], v[86:89]
    s_waitcnt vmcnt(4) lgkmcnt(10)
    v_mfma_f32_16x16x32_bf16 v[70:73], v[90:93], v[62:65], v[70:73]
    v_mfma_f32_16x16x32_bf16 v[74:77], v[94:97], v[62:65], v[74:77]
    v_mfma_f32_16x16x32_bf16 v[78:81], v[98:101], v[62:65], v[78:81]
    v_mfma_f32_16x16x32_bf16 v[82:85], v[102:105], v[62:65], v[82:85]
    v_mfma_f32_16x16x32_bf16 v[86:89], v[106:109], v[62:65], v[86:89]
    s_waitcnt vmcnt(0) lgkmcnt(0)
    v_mfma_f32_16x16x32_bf16 v[70:73], v[110:113], v[66:69], v[70:73]
    v_mfma_f32_16x16x32_bf16 v[74:77], v[114:117], v[66:69], v[74:77]
    v_mfma_f32_16x16x32_bf16 v[78:81], v[118:121], v[66:69], v[78:81]
    v_mfma_f32_16x16x32_bf16 v[82:85], v[122:125], v[66:69], v[82:85]
    v_mfma_f32_16x16x32_bf16 v[86:89], v[126:129], v[66:69], v[86:89]
    s_branch p3_done
    s_branch p3_loop
p3_mm:
    s_bitcmp0_b32 s48, 12
    s_cbranch_scc1 p3_r6
    ds_read_b64_tr_b16 v[224:225], v15 offset:30720
    ds_read_b64_tr_b16 v[226:227], v15 offset:32000
    ds_read_b64_tr_b16 v[228:229], v15 offset:30752
    ds_read_b64_tr_b16 v[230:231], v15 offset:32032
    ds_read_b64_tr_b16 v[232:233], v15 offset:30784
    ds_read_b64_tr_b16 v[234:235], v15 offset:32064
    ds_read_b64_tr_b16 v[236:237], v15 offset:30816
    ds_read_b64_tr_b16 v[238:239], v15 offset:32096
    ds_read_b64_tr_b16 v[240:241], v15 offset:30848
    ds_read_b64_tr_b16 v[242:243], v15 offset:32128
p3_r6:
    s_bitcmp0_b32 s48, 0
    s_cbranch_scc1 p3_m0
    v_mfma_f32_16x16x32_bf16 v[70:73], v[90:93], v[34:37], v[70:73]
    v_mfma_f32_16x16x32_bf16 v[74:77], v[94:97], v[34:37], v[74:77]
    v_mfma_f32_16x16x32_bf16 v[78:81], v[98:101], v[34:37], v[78:81]
    v_mfma_f32_16x16x32_bf16 v[82:85], v[102:105], v[34:37], v[82:85]
    v_mfma_f32_16x16x32_bf16 v[86:89], v[106:109], v[34:37], v[86:89]
p3_m0:
    s_bitcmp0_b32 s48, 2
    s_cbranch_scc1 p3_m1
    v_mfma_f32_16x16x32_bf16 v[70:73], v[110:113], v[38:41], v[70:73]
    v_mfma_f32_16x16x32_bf16 v[74:77], v[114:117], v[38:41], v[74:77]
    v_mfma_f32_16x16x32_bf16 v[78:81], v[118:121], v[38:41], v[78:81]
    v_mfma_f32_16x16x32_bf16 v[82:85], v[122:125], v[38:41], v[82:85]
    v_mfma_f32_16x16x32_bf16 v[86:89], v[126:129], v[38:41], v[86:89]
p3_m1:
    s_bitcmp0_b32 s48, 12
    s_cbranch_scc1 p3_m6
    s_waitcnt lgkmcnt(0)
    v_mfma_f32_16x16x32_bf16 v[70:73], v[224:227], v[58:61], v[70:73]
    v_mfma_f32_16x16x32_bf16 v[74:77], v[228:231], v[58:61], v[74:77]
    v_mfma_f32_16x16x32_bf16 v[78:81], v[232:235], v[58:61], v[78:81]
    v_mfma_f32_16x16x32_bf16 v[82:85], v[236:239], v[58:61], v[82:85]
    v_mfma_f32_16x16x32_bf16 v[86:89], v[240:243], v[58:61], v[86:89]
p3_m6:
    s_bitcmp0_b32 s48, 14
    s_cbranch_scc1 p3_r7
    ds_read_b64_tr_b16 v[224:225], v15 offset:35840
    ds_read_b64_tr_b16 v[226:227], v15 offset:37120
    ds_read_b64_tr_b16 v[228:229], v15 offset:35872
    ds_read_b64_tr_b16 v[230:231], v15 offset:37152
    ds_read_b64_tr_b16 v[232:233], v15 offset:35904
    ds_read_b64_tr_b16 v[234:235], v15 offset:37184
    ds_read_b64_tr_b16 v[236:237], v15 offset:35936
    ds_read_b64_tr_b16 v[238:239], v15 offset:37216
    ds_read_b64_tr_b16 v[240:241], v15 offset:35968
    ds_read_b64_tr_b16 v[242:243], v15 offset:37248
p3_r7:
    s_bitcmp0_b32 s48, 4
    s_cbranch_scc1 p3_m2
    v_mfma_f32_16x16x32_bf16 v[70:73], v[130:133], v[42:45], v[70:73]
    v_mfma_f32_16x16x32_bf16 v[74:77], v[134:137], v[42:45], v[74:77]
    v_mfma_f32_16x16x32_bf16 v[78:81], v[138:141], v[42:45], v[78:81]
    v_mfma_f32_16x16x32_bf16 v[82:85], v[142:145], v[42:45], v[82:85]
    v_mfma_f32_16x16x32_bf16 v[86:89], v[146:149], v[42:45], v[86:89]
p3_m2:
    s_bitcmp0_b32 s48, 6
    s_cbranch_scc1 p3_m3
    v_mfma_f32_16x16x32_bf16 v[70:73], v[150:153], v[46:49], v[70:73]
    v_mfma_f32_16x16x32_bf16 v[74:77], v[154:157], v[46:49], v[74:77]
    v_mfma_f32_16x16x32_bf16 v[78:81], v[158:161], v[46:49], v[78:81]
    v_mfma_f32_16x16x32_bf16 v[82:85], v[162:165], v[46:49], v[82:85]
    v_mfma_f32_16x16x32_bf16 v[86:89], v[166:169], v[46:49], v[86:89]
p3_m3:
    s_bitcmp0_b32 s48, 14
    s_cbranch_scc1 p3_m7
    s_waitcnt lgkmcnt(0)
    v_mfma_f32_16x16x32_bf16 v[70:73], v[224:227], v[62:65], v[70:73]
    v_mfma_f32_16x16x32_bf16 v[74:77], v[228:231], v[62:65], v[74:77]
    v_mfma_f32_16x16x32_bf16 v[78:81], v[232:235], v[62:65], v[78:81]
    v_mfma_f32_16x16x32_bf16 v[82:85], v[236:239], v[62:65], v[82:85]
    v_mfma_f32_16x16x32_bf16 v[86:89], v[240:243], v[62:65], v[86:89]
p3_m7:
    s_bitcmp0_b32 s48, 16
    s_cbranch_scc1 p3_r8
    ds_read_b64_tr_b16 v[224:225], v15 offset:40960
    ds_read_b64_tr_b16 v[226:227], v15 offset:42240
    ds_read_b64_tr_b16 v[228:229], v15 offset:40992
    ds_read_b64_tr_b16 v[230:231], v15 offset:42272
    ds_read_b64_tr_b16 v[232:233], v15 offset:41024
    ds_read_b64_tr_b16 v[234:235], v15 offset:42304
    ds_read_b64_tr_b16 v[236:237], v15 offset:41056
    ds_read_b64_tr_b16 v[238:239], v15 offset:42336
    ds_read_b64_tr_b16 v[240:241], v15 offset:41088
    ds_read_b64_tr_b16 v[242:243], v15 offset:42368
p3_r8:
    s_bitcmp0_b32 s48, 8
    s_cbranch_scc1 p3_m4
    v_mfma_f32_16x16x32_bf16 v[70:73], v[170:173], v[50:53], v[70:73]
    v_mfma_f32_16x16x32_bf16 v[74:77], v[174:177], v[50:53], v[74:77]
    v_mfma_f32_16x16x32_bf16 v[78:81], v[178:181], v[50:53], v[78:81]
    v_mfma_f32_16x16x32_bf16 v[82:85], v[182:185], v[50:53], v[82:85]
    v_mfma_f32_16x16x32_bf16 v[86:89], v[186:189], v[50:53], v[86:89]
p3_m4:
    s_bitcmp0_b32 s48, 10
    s_cbranch_scc1 p3_m5
    v_mfma_f32_16x16x32_bf16 v[70:73], v[190:193], v[54:57], v[70:73]
    v_mfma_f32_16x16x32_bf16 v[74:77], v[194:197], v[54:57], v[74:77]
    v_mfma_f32_16x16x32_bf16 v[78:81], v[198:201], v[54:57], v[78:81]
    v_mfma_f32_16x16x32_bf16 v[82:85], v[202:205], v[54:57], v[82:85]
    v_mfma_f32_16x16x32_bf16 v[86:89], v[206:209], v[54:57], v[86:89]
p3_m5:
    s_bitcmp0_b32 s48, 16
    s_cbranch_scc1 p3_m8
    s_waitcnt lgkmcnt(0)
    v_mfma_f32_16x16x32_bf16 v[70:73], v[224:227], v[66:69], v[70:73]
    v_mfma_f32_16x16x32_bf16 v[74:77], v[228:231], v[66:69], v[74:77]
    v_mfma_f32_16x16x32_bf16 v[78:81], v[232:235], v[66:69], v[78:81]
    v_mfma_f32_16x16x32_bf16 v[82:85], v[236:239], v[66:69], v[82:85]
    v_mfma_f32_16x16x32_bf16 v[86:89], v[240:243], v[66:69], v[86:89]
p3_m8:
    s_cmp_eq_u32 s57, 0x15555
    s_cbranch_scc1 p3_done
    s_or_b32 s50, s59, s48
    s_cbranch_scc1 p3_loop
    s_sleep 4
    s_branch p3_loop
p3_done:
    s_lshl_b32 s50, s47, 2
    v_add_u32 v2, s50, v255
    s_cmp_eq_u32 s46, 0
    s_cbranch_scc1 p3_fin
    v_mov_b32 v3, 1
    s_nop 2
    ds_write_b128 v22, v[70:73] offset:0
    ds_write_b128 v22, v[74:77] offset:1024
    ds_write_b128 v22, v[78:81] offset:2048
    ds_write_b128 v22, v[82:85] offset:3072
    ds_write_b128 v22, v[86:89] offset:4096
    s_waitcnt lgkmcnt(0)
    ds_write_b32 v2, v3 offset:64
    s_branch p3_end
p3_fin:
    v_cmp_ne_u32 vcc, s100, v17
    s_cbranch_vccz p3_g_x
    s_mov_b32 s50, 65536
p3_g:
    buffer_load_dwordx2 v[16:17], v14, s[24:27], 0 offen sc1
    s_sub_u32 s50, s50, 1
    s_cbranch_scc1 p3_g_x
    s_waitcnt vmcnt(0)
    v_cmp_ne_u32 vcc, s100, v17
    s_cbranch_vccnz p3_g
p3_g_x:
    v_sub_f32 v17, 1.0, v16
    v_cvt_pk_bf16_f32 v17, v17, v17
    v_lshlrev_b32 v17, 16, v17
    v_add_u32 v5, 0, v1
    v_mul_u32_u24 v7, 7282, v5
    v_lshrrev_b32 v7, 16, v7
    v_mul_u32_u24 v7, 1008, v7
    v_lshl_add_u32 v130, v5, 4, v7
    v_add_u32 v5, 64, v1
    v_mul_u32_u24 v7, 7282, v5
    v_lshrrev_b32 v7, 16, v7
    v_mul_u32_u24 v7, 1008, v7
    v_lshl_add_u32 v131, v5, 4, v7
    v_add_u32 v5, 128, v1
    v_mul_u32_u24 v7, 7282, v5
    v_lshrrev_b32 v7, 16, v7
    v_mul_u32_u24 v7, 1008, v7
    v_lshl_add_u32 v132, v5, 4, v7
    s_mul_i32 s50, s47, 2304
    s_add_u32 s50, s50, 138240
    v_lshl_add_u32 v133, v1, 4, s50
    v_lshlrev_b32 v110, 16, v24
    v_and_b32 v111, 0xffff0000, v24
    v_pk_mul_f32 v[110:111], v[110:111], v[16:17] op_sel:[0,1] op_sel_hi:[1,1]
    v_pk_fma_f32 v[110:111], v[70:71], v[16:17], v[110:111] op_sel_hi:[1,0,1]
    v_lshlrev_b32 v112, 16, v25
    v_and_b32 v113, 0xffff0000, v25
    v_pk_mul_f32 v[112:113], v[112:113], v[16:17] op_sel:[0,1] op_sel_hi:[1,1]
    v_pk_fma_f32 v[112:113], v[72:73], v[16:17], v[112:113] op_sel_hi:[1,0,1]
    v_lshlrev_b32 v114, 16, v26
    v_and_b32 v115, 0xffff0000, v26
    v_pk_mul_f32 v[114:115], v[114:115], v[16:17] op_sel:[0,1] op_sel_hi:[1,1]
    v_pk_fma_f32 v[114:115], v[74:75], v[16:17], v[114:115] op_sel_hi:[1,0,1]
    v_lshlrev_b32 v116, 16, v27
    v_and_b32 v117, 0xffff0000, v27
    v_pk_mul_f32 v[116:117], v[116:117], v[16:17] op_sel:[0,1] op_sel_hi:[1,1]
    v_pk_fma_f32 v[116:117], v[76:77], v[16:17], v[116:117] op_sel_hi:[1,0,1]
    v_lshlrev_b32 v118, 16, v28
    v_and_b32 v119, 0xffff0000, v28
    v_pk_mul_f32 v[118:119], v[118:119], v[16:17] op_sel:[0,1] op_sel_hi:[1,1]
    v_pk_fma_f32 v[118:119], v[78:79], v[16:17], v[118:119] op_sel_hi:[1,0,1]
    v_lshlrev_b32 v120, 16, v29
    v_and_b32 v121, 0xffff0000, v29
    v_pk_mul_f32 v[120:121], v[120:121], v[16:17] op_sel:[0,1] op_sel_hi:[1,1]
    v_pk_fma_f32 v[120:121], v[80:81], v[16:17], v[120:121] op_sel_hi:[1,0,1]
    v_lshlrev_b32 v122, 16, v30
    v_and_b32 v123, 0xffff0000, v30
    v_pk_mul_f32 v[122:123], v[122:123], v[16:17] op_sel:[0,1] op_sel_hi:[1,1]
    v_pk_fma_f32 v[122:123], v[82:83], v[16:17], v[122:123] op_sel_hi:[1,0,1]
    v_lshlrev_b32 v124, 16, v31
    v_and_b32 v125, 0xffff0000, v31
    v_pk_mul_f32 v[124:125], v[124:125], v[16:17] op_sel:[0,1] op_sel_hi:[1,1]
    v_pk_fma_f32 v[124:125], v[84:85], v[16:17], v[124:125] op_sel_hi:[1,0,1]
    v_lshlrev_b32 v126, 16, v32
    v_and_b32 v127, 0xffff0000, v32
    v_pk_mul_f32 v[126:127], v[126:127], v[16:17] op_sel:[0,1] op_sel_hi:[1,1]
    v_pk_fma_f32 v[126:127], v[86:87], v[16:17], v[126:127] op_sel_hi:[1,0,1]
    v_lshlrev_b32 v128, 16, v33
    v_and_b32 v129, 0xffff0000, v33
    v_pk_mul_f32 v[128:129], v[128:129], v[16:17] op_sel:[0,1] op_sel_hi:[1,1]
    v_pk_fma_f32 v[128:129], v[88:89], v[16:17], v[128:129] op_sel_hi:[1,0,1]
    s_mov_b32 s51, 1048576
p3_rs:
    ds_read_b32 v6, v2 offset:64
    s_sub_u32 s51, s51, 1
    s_cbranch_scc1 p3_rs_x
    s_waitcnt lgkmcnt(0)
    v_readfirstlane_b32 s50, v6
    s_cmp_ge_u32 s50, 1
    s_cbranch_scc1 p3_rs_x
    s_sleep 1
    s_branch p3_rs
p3_rs_x:
    ds_read_b128 v[90:93], v22 offset:0
    ds_read_b128 v[94:97], v22 offset:1024
    ds_read_b128 v[98:101], v22 offset:2048
    ds_read_b128 v[102:105], v22 offset:3072
    ds_read_b128 v[106:109], v22 offset:4096
    s_waitcnt lgkmcnt(4)
    v_pk_fma_f32 v[110:111], v[90:91], v[16:17], v[110:111] op_sel_hi:[1,0,1]
    v_cvt_pk_bf16_f32 v34, v110, v111
    v_pk_fma_f32 v[112:113], v[92:93], v[16:17], v[112:113] op_sel_hi:[1,0,1]
    v_cvt_pk_bf16_f32 v35, v112, v113
    ds_write_b64 v21, v[34:35] offset:0
    s_waitcnt lgkmcnt(4)
    v_pk_fma_f32 v[114:115], v[94:95], v[16:17], v[114:115] op_sel_hi:[1,0,1]
    v_cvt_pk_bf16_f32 v36, v114, v115
    v_pk_fma_f32 v[116:117], v[96:97], v[16:17], v[116:117] op_sel_hi:[1,0,1]
    v_cvt_pk_bf16_f32 v37, v116, v117
    ds_write_b64 v21, v[36:37] offset:32
    s_waitcnt lgkmcnt(4)
    v_pk_fma_f32 v[118:119], v[98:99], v[16:17], v[118:119] op_sel_hi:[1,0,1]
    v_cvt_pk_bf16_f32 v38, v118, v119
    v_pk_fma_f32 v[120:121], v[100:101], v[16:17], v[120:121] op_sel_hi:[1,0,1]
    v_cvt_pk_bf16_f32 v39, v120, v121
    ds_write_b64 v21, v[38:39] offset:64
    s_waitcnt lgkmcnt(4)
    v_pk_fma_f32 v[122:123], v[102:103], v[16:17], v[122:123] op_sel_hi:[1,0,1]
    v_cvt_pk_bf16_f32 v40, v122, v123
    v_pk_fma_f32 v[124:125], v[104:105], v[16:17], v[124:125] op_sel_hi:[1,0,1]
    v_cvt_pk_bf16_f32 v41, v124, v125
    ds_write_b64 v21, v[40:41] offset:96
    s_waitcnt lgkmcnt(4)
    v_pk_fma_f32 v[126:127], v[106:107], v[16:17], v[126:127] op_sel_hi:[1,0,1]
    v_cvt_pk_bf16_f32 v42, v126, v127
    v_pk_fma_f32 v[128:129], v[108:109], v[16:17], v[128:129] op_sel_hi:[1,0,1]
    v_cvt_pk_bf16_f32 v43, v128, v129
    s_mov_b32 exec_hi, 0
    ds_write_b64 v21, v[42:43] offset:128
    s_mov_b64 exec, -1
    ds_read_b128 v[72:75], v133 offset:0
    ds_read_b128 v[76:79], v133 offset:1024
    ds_read_b128 v[80:83], v133 offset:2048
    s_waitcnt lgkmcnt(2)
    buffer_store_dwordx4 v[72:75], v130, s[28:31], s54 offen
    s_waitcnt lgkmcnt(1)
    buffer_store_dwordx4 v[76:79], v131, s[28:31], s54 offen
    s_waitcnt lgkmcnt(0)
    s_mov_b64 exec, 0xffff
    buffer_store_dwordx4 v[80:83], v132, s[28:31], s54 offen
    s_mov_b64 exec, -1
p3_end:
f_exit:
    s_endpgm
.p2align 4
code_end:
    s_endpgm
.section .rodata,"a"
.p2align 6
.amdhsa_kernel gated_mix__sliding_block__ssm_conv_h3__prompt_kernel
  .amdhsa_next_free_vgpr 256
  .amdhsa_next_free_sgpr 102
  .amdhsa_accum_offset 256
  .amdhsa_group_segment_fixed_size 0
  .amdhsa_kernarg_size 104
  .amdhsa_user_sgpr_count 2
  .amdhsa_user_sgpr_kernarg_segment_ptr 1
  .amdhsa_system_sgpr_workgroup_id_x 1
  .amdhsa_float_denorm_mode_32 3
.end_amdhsa_kernel
```
